```python
import torch

def _softmax(x, axis=-1):
    return torch.softmax(x, dim=axis)
def _gelu(x):
    return torch.nn.functional.gelu(x, approximate="tanh")
def _silu(x):
    return torch.nn.functional.silu(x)
def _sigmoid(x):
    return torch.sigmoid(x)
def _layernorm(x, axis=-1, eps=1e-5):
    m = x.mean(dim=axis, keepdim=True)
    v = x.var(dim=axis, keepdim=True, unbiased=False)
    return (x - m) / torch.sqrt(v + eps)
def _scatter_add(tgt, idx, src, axis=0):
    return tgt.clone().index_add_(axis, idx, src)
def _segment_sum(src, seg, n):
    out = torch.zeros((n,) + src.shape[1:], dtype=src.dtype)
    return out.index_add_(0, seg, src)
def _pad(x, pw):
    flat = tuple(v for pair in reversed(pw) for v in pair)
    return torch.nn.functional.pad(x, flat)

kernel_name = 'standalone__mha_block_cached__near_ridge'

def setup_inputs():

    _w = (lambda a: (lambda t: t.to(torch.bfloat16) if t.is_floating_point() else t)(torch.as_tensor(a)))
    B, Sq, D = 16, 64, 512
    H, Sk, Dh = 32, 64, 128
    return {
        "x": _w((lambda *s: torch.randn(*s, dtype=torch.bfloat16) * 0.8)(B, Sq, D)),
        "k_cache": _w((lambda *s: torch.randn(*s, dtype=torch.bfloat16) * 0.8)(B, H, Sk, Dh)),
        "v_cache": _w((lambda *s: torch.randn(*s, dtype=torch.bfloat16) * 0.05)(B, H, Sk, Dh)),
        "wq": _w((lambda *s: torch.randn(*s, dtype=torch.bfloat16) * 0.8)(D, H * Dh) * (D ** -0.5)),
        "wo": _w((lambda *s: torch.randn(*s, dtype=torch.bfloat16) * 0.05)(H * Dh, D) * ((H * Dh) ** -0.5)),
    }

def reference(x, k_cache, v_cache, wq, wo):
    B, Sq, D = x.shape
    H, Dh = 32, 128
    q = (lambda x, *d: x.permute(*d))((x @ wq).reshape(B, Sq, H, Dh), 0, 2, 1, 3)
    scores = torch.einsum("bhqd,bhkd->bhqk", q, k_cache) * (Dh ** -0.5)
    p = _softmax(scores, axis=-1)
    o = torch.einsum("bhqk,bhkd->bhqd", p, v_cache)
    return (lambda x, *d: x.permute(*d))(o, 0, 2, 1, 3).reshape(B, Sq, H * Dh) @ wo
```

```asm
; @launch grid=(256,1,1) block=(512,1,1) lds=163840
.amdgcn_target "amdgcn-amd-amdhsa--gfx950"
.text
.globl standalone__mha_block_cached__near_ridge_kernel
.type standalone__mha_block_cached__near_ridge_kernel,@function
.p2align 12
.p2align 8
standalone__mha_block_cached__near_ridge_kernel:
    s_load_dwordx2 s[32:33], s[0:1], 0
    s_load_dwordx2 s[44:45], s[0:1], 24
    s_load_dwordx16 s[16:31], s[0:1], 0
    s_cmp_ge_u32 s2, 256
    s_cbranch_scc1 L_end
    v_readfirstlane_b32 s3, v0
    s_and_b32 s4, s2, 7
    s_bfe_u32 s8, s2, 0x20003
    s_lshr_b32 s11, s2, 5
    s_bitcmp1_b32 s3, 8
    s_cbranch_scc1 L_loader
    s_lshr_b32 s3, s3, 6
    v_and_b32 v0, 63, v0
    s_getpc_b64 s[6:7]
L_pc:
    s_lshl_b32 s13, s8, 2
    s_add_u32 s13, s13, s3
    s_mul_i32 s13, s13, ((L_codeend-L_pc)/1024+1)*64
    v_min_u32 v1, ((L_codeend-L_pc)/1024+1)-1, v0
    v_lshlrev_b32 v1, 6, v1
    v_add_u32 v1, s13, v1
    v_min_u32 v1, L_codeend-L_pc-4, v1
    global_load_dword v130, v1, s[6:7]
    s_lshl1_add_u32 s9, s11, s8
    s_and_b32 s9, s9, 3
    s_branch L_compute
L_loader:
    s_mov_b32 s34, 0x100000
    s_mov_b32 s35, 0x20000
    s_mov_b32 s46, 0x400000
    s_mov_b32 s47, 0x20000
    v_bfe_u32 v6, v0, 4, 4
    v_bfe_u32 v1, v0, 3, 5
    v_xor_b32 v2, v6, v0
    v_and_b32 v2, 7, v2
    v_lshlrev_b32 v2, 4, v2
    v_lshl_add_u32 v8, v1, 10, v2
    v_bfe_u32 v5, v0, 7, 1
    v_lshlrev_b32 v5, 2, v5
    v_xor_b32 v5, v5, v6
    v_lshlrev_b32 v5, 1, v5
    v_xor_b32 v5, v5, v0
    v_and_b32 v5, 15, v5
    v_lshlrev_b32 v5, 4, v5
    v_lshl_add_u32 v9, v6, 13, v5
    s_xor_b32 s74, s4, 7
    s_lshl_b32 s13, s74, 14
    s_and_b32 s14, s13, 0x4000
    v_xor_b32 v8, s14, v8
    s_xor_b32 s13, s13, s14
    s_lshl_b32 s64, s11, 17
    s_add_u32 s64, s64, s13
    s_lshl2_add_u32 s10, s4, s8
    s_lshl_b32 s65, s10, 8
    s_add_u32 s12, s8, s11
    s_lshl2_add_u32 s12, s12, s4
    s_lshl_b32 s13, s11, 1
    s_cmp_eq_u32 s4, 0
    s_cselect_b32 s12, s13, s12
    s_bfe_u32 s3, s3, 0x20006
    s_lshl_b32 s67, s3, 10
    s_add_u32 s13, s12, 0
    s_and_b32 s13, s13, 7
    s_lshl_b32 s14, s13, 7
    s_add_u32 s14, s14, s64
    s_add_u32 s13, s12, 0
    s_and_b32 s13, s13, 7
    s_lshl_b32 s15, s13, 19
    s_add_u32 s15, s15, s65
    s_add_u32 m0, s67, 0
    s_xor_b32 s68, s14, 0x0
    s_waitcnt lgkmcnt(0)
    buffer_load_dwordx4 v8, s[32:35], s68 offen  lds
    s_addk_i32 m0, 0x1000
    s_xor_b32 s68, s14, 0x8000
    buffer_load_dwordx4 v8, s[32:35], s68 offen  lds
    s_addk_i32 m0, 0x1000
    s_xor_b32 s68, s14, 0x10000
    buffer_load_dwordx4 v8, s[32:35], s68 offen  lds
    s_addk_i32 m0, 0x1000
    s_xor_b32 s68, s14, 0x18000
    buffer_load_dwordx4 v8, s[32:35], s68 offen  lds
    s_add_u32 m0, s67, 65536
    s_add_u32 s68, s15, 0
    buffer_load_dwordx4 v9, s[44:47], s68 offen  lds
    s_addk_i32 m0, 0x1000
    s_add_u32 s68, s15, 131072
    buffer_load_dwordx4 v9, s[44:47], s68 offen  lds
    s_addk_i32 m0, 0x1000
    s_add_u32 s68, s15, 262144
    buffer_load_dwordx4 v9, s[44:47], s68 offen  lds
    s_addk_i32 m0, 0x1000
    s_add_u32 s68, s15, 393216
    buffer_load_dwordx4 v9, s[44:47], s68 offen  lds
    s_mov_b32 s38, 0x800000
    s_mov_b32 s39, 0x20000
    s_mov_b32 s42, 0x800000
    s_mov_b32 s43, 0x20000
    s_mov_b32 s50, 0x400000
    s_mov_b32 s51, 0x20000
    s_mov_b32 s54, 0x100000
    s_mov_b32 s55, 0x20000
    s_mov_b32 s62, 0x100
    s_mov_b32 s63, 0x20000
    s_mov_b32 s58, 0x10000000
    s_mov_b32 s59, 0x20000
    s_mov_b64 s[36:37], s[18:19]
    s_mov_b64 s[40:41], s[20:21]
    s_mov_b64 s[48:49], s[24:25]
    s_mov_b64 s[52:53], s[26:27]
    s_mov_b64 s[60:61], s[28:29]
    s_mov_b64 s[56:57], s[30:31]
    v_lshl_add_u32 v11, v1, 8, v2
    v_and_b32 v0, 63, v0
    v_and_b32 v3, 7, v0
    v_and_b32 v4, 15, v0
    s_lshr_b32 s5, s2, 3
    s_lshl1_add_u32 s9, s11, s8
    s_and_b32 s9, s9, 3
    s_lshl_b32 s13, s11, 15
    s_lshl_b32 s14, s4, 10
    s_add_u32 s13, s13, s14
    s_add_u32 s79, s13, 4194304
    s_lshl_b32 s14, s9, 13
    s_add_u32 s77, s79, s14
    v_mov_b32 v17, 0
    v_lshl_add_u32 v12, v6, 10, v5
    v_xor_b32 v5, v6, v4
    v_lshlrev_b32 v5, 4, v5
    v_lshl_add_u32 v10, v6, 8, v5
    v_lshlrev_b32 v13, 4, v0
    s_lshl_b32 s69, s11, 20
    s_lshr_b32 s13, s74, 2
    s_lshl_b32 s13, s13, 19
    s_add_u32 s69, s69, s13
    s_lshl_b32 s13, s10, 14
    s_add_u32 s66, s69, s13
    s_lshl_b32 s13, s4, 16
    s_add_u32 s69, s69, s13
    s_lshl_b32 s70, s4, 19
    s_lshl_b32 s13, s9, 8
    s_add_u32 s70, s70, s13
    s_bfe_u32 s71, s11, 0x10002
    s_lshl_b32 s72, s11, 3
    s_add_u32 s72, s72, s4
    s_lshl_b32 s73, s72, 16
    s_lshl_b32 s13, s3, 12
    v_add_u32 v14, s13, v13
    v_lshlrev_b32 v19, 2, v3
    s_lshl_b32 s13, s11, 5
    v_add_u32 v19, s13, v19
    s_mov_b32 s76, 0
    s_add_u32 s13, s12, 1
    s_and_b32 s13, s13, 7
    s_lshl_b32 s14, s13, 7
    s_add_u32 s14, s14, s64
    s_add_u32 s13, s12, 1
    s_and_b32 s13, s13, 7
    s_lshl_b32 s15, s13, 19
    s_add_u32 s15, s15, s65
    s_add_u32 m0, s67, 16384
    s_xor_b32 s68, s14, 0x0
    buffer_load_dwordx4 v8, s[32:35], s68 offen  lds
    s_addk_i32 m0, 0x1000
    s_xor_b32 s68, s14, 0x8000
    buffer_load_dwordx4 v8, s[32:35], s68 offen  lds
    s_addk_i32 m0, 0x1000
    s_xor_b32 s68, s14, 0x10000
    buffer_load_dwordx4 v8, s[32:35], s68 offen  lds
    s_addk_i32 m0, 0x1000
    s_xor_b32 s68, s14, 0x18000
    buffer_load_dwordx4 v8, s[32:35], s68 offen  lds
    s_add_u32 m0, s67, 81920
    s_add_u32 s68, s15, 0
    buffer_load_dwordx4 v9, s[44:47], s68 offen  lds
    s_addk_i32 m0, 0x1000
    s_add_u32 s68, s15, 131072
    buffer_load_dwordx4 v9, s[44:47], s68 offen  lds
    s_addk_i32 m0, 0x1000
    s_add_u32 s68, s15, 262144
    buffer_load_dwordx4 v9, s[44:47], s68 offen  lds
    s_addk_i32 m0, 0x1000
    s_add_u32 s68, s15, 393216
    buffer_load_dwordx4 v9, s[44:47], s68 offen  lds
    s_cmp_lg_u32 s3, 0
    s_cbranch_scc1 L_k1
    v_lshlrev_b32 v1, 4, v0
    v_mov_b32 v28, 0
    v_mov_b32 v29, 0
    v_mov_b32 v30, 0
    v_mov_b32 v31, 0
    buffer_store_dwordx4 v[28:31], v1, s[56:59], s77 offen sc1
L_k1:
    s_waitcnt vmcnt(8)
    s_barrier
    s_add_u32 s13, s12, 2
    s_and_b32 s13, s13, 7
    s_lshl_b32 s14, s13, 7
    s_add_u32 s14, s14, s64
    s_add_u32 s13, s12, 2
    s_and_b32 s13, s13, 7
    s_lshl_b32 s15, s13, 19
    s_add_u32 s15, s15, s65
    s_add_u32 m0, s67, 32768
    s_xor_b32 s68, s14, 0x0
    buffer_load_dwordx4 v8, s[32:35], s68 offen  lds
    s_addk_i32 m0, 0x1000
    s_xor_b32 s68, s14, 0x8000
    buffer_load_dwordx4 v8, s[32:35], s68 offen  lds
    s_addk_i32 m0, 0x1000
    s_xor_b32 s68, s14, 0x10000
    buffer_load_dwordx4 v8, s[32:35], s68 offen  lds
    s_addk_i32 m0, 0x1000
    s_xor_b32 s68, s14, 0x18000
    buffer_load_dwordx4 v8, s[32:35], s68 offen  lds
    s_add_u32 m0, s67, 98304
    s_add_u32 s68, s15, 0
    buffer_load_dwordx4 v9, s[44:47], s68 offen  lds
    s_addk_i32 m0, 0x1000
    s_add_u32 s68, s15, 131072
    buffer_load_dwordx4 v9, s[44:47], s68 offen  lds
    s_addk_i32 m0, 0x1000
    s_add_u32 s68, s15, 262144
    buffer_load_dwordx4 v9, s[44:47], s68 offen  lds
    s_addk_i32 m0, 0x1000
    s_add_u32 s68, s15, 393216
    buffer_load_dwordx4 v9, s[44:47], s68 offen  lds
    s_waitcnt vmcnt(8)
    s_barrier
    s_bfe_u32 s78, s5, 0x10004
    s_cmp_eq_u32 s78, 1
    s_cbranch_scc1 L_g1
    s_cmp_lg_u32 s3, 0
    s_cbranch_scc1 L_k2
    s_waitcnt vmcnt(8)
    s_lshl_b32 s13, s72, 2
    v_mov_b32 v2, 1
    s_mov_b64 exec, 1
    buffer_atomic_add v2, v17, s[60:63], s13 offen
    s_mov_b64 exec, -1
L_k2:
    s_add_u32 m0, s67, 131072
    s_xor_b32 s68, s66, 0x0
    buffer_load_dwordx4 v10, s[36:39], s68 offen nt lds
    s_addk_i32 m0, 0x1000
    s_xor_b32 s68, s66, 0x1000
    buffer_load_dwordx4 v10, s[36:39], s68 offen nt lds
    s_addk_i32 m0, 0x1000
    s_xor_b32 s68, s66, 0x2000
    buffer_load_dwordx4 v10, s[36:39], s68 offen nt lds
    s_addk_i32 m0, 0x1000
    s_xor_b32 s68, s66, 0x3000
    buffer_load_dwordx4 v10, s[36:39], s68 offen nt lds
    s_add_u32 s13, s12, 3
    s_and_b32 s13, s13, 7
    s_lshl_b32 s14, s13, 7
    s_add_u32 s14, s14, s64
    s_add_u32 s13, s12, 3
    s_and_b32 s13, s13, 7
    s_lshl_b32 s15, s13, 19
    s_add_u32 s15, s15, s65
    s_add_u32 m0, s67, 49152
    s_xor_b32 s68, s14, 0x0
    buffer_load_dwordx4 v8, s[32:35], s68 offen  lds
    s_addk_i32 m0, 0x1000
    s_xor_b32 s68, s14, 0x8000
    buffer_load_dwordx4 v8, s[32:35], s68 offen  lds
    s_addk_i32 m0, 0x1000
    s_xor_b32 s68, s14, 0x10000
    buffer_load_dwordx4 v8, s[32:35], s68 offen  lds
    s_addk_i32 m0, 0x1000
    s_xor_b32 s68, s14, 0x18000
    buffer_load_dwordx4 v8, s[32:35], s68 offen  lds
    s_add_u32 m0, s67, 114688
    s_add_u32 s68, s15, 0
    buffer_load_dwordx4 v9, s[44:47], s68 offen  lds
    s_addk_i32 m0, 0x1000
    s_add_u32 s68, s15, 131072
    buffer_load_dwordx4 v9, s[44:47], s68 offen  lds
    s_addk_i32 m0, 0x1000
    s_add_u32 s68, s15, 262144
    buffer_load_dwordx4 v9, s[44:47], s68 offen  lds
    s_addk_i32 m0, 0x1000
    s_add_u32 s68, s15, 393216
    buffer_load_dwordx4 v9, s[44:47], s68 offen  lds
    s_waitcnt vmcnt(12)
    s_barrier
    s_add_u32 s13, s12, 4
    s_and_b32 s13, s13, 7
    s_lshl_b32 s14, s13, 7
    s_add_u32 s14, s14, s64
    s_add_u32 s13, s12, 4
    s_and_b32 s13, s13, 7
    s_lshl_b32 s15, s13, 19
    s_add_u32 s15, s15, s65
    s_add_u32 m0, s67, 0
    s_xor_b32 s68, s14, 0x0
    buffer_load_dwordx4 v8, s[32:35], s68 offen  lds
    s_addk_i32 m0, 0x1000
    s_xor_b32 s68, s14, 0x8000
    buffer_load_dwordx4 v8, s[32:35], s68 offen  lds
    s_addk_i32 m0, 0x1000
    s_xor_b32 s68, s14, 0x10000
    buffer_load_dwordx4 v8, s[32:35], s68 offen  lds
    s_addk_i32 m0, 0x1000
    s_xor_b32 s68, s14, 0x18000
    buffer_load_dwordx4 v8, s[32:35], s68 offen  lds
    s_add_u32 m0, s67, 65536
    s_add_u32 s68, s15, 0
    buffer_load_dwordx4 v9, s[44:47], s68 offen  lds
    s_addk_i32 m0, 0x1000
    s_add_u32 s68, s15, 131072
    buffer_load_dwordx4 v9, s[44:47], s68 offen  lds
    s_addk_i32 m0, 0x1000
    s_add_u32 s68, s15, 262144
    buffer_load_dwordx4 v9, s[44:47], s68 offen  lds
    s_addk_i32 m0, 0x1000
    s_add_u32 s68, s15, 393216
    buffer_load_dwordx4 v9, s[44:47], s68 offen  lds
    s_waitcnt vmcnt(8)
    s_barrier
    s_add_u32 m0, s67, 147456
    s_xor_b32 s68, s66, 0x80000
    buffer_load_dwordx4 v10, s[36:39], s68 offen nt lds
    s_addk_i32 m0, 0x1000
    s_xor_b32 s68, s66, 0x81000
    buffer_load_dwordx4 v10, s[36:39], s68 offen nt lds
    s_addk_i32 m0, 0x1000
    s_xor_b32 s68, s66, 0x82000
    buffer_load_dwordx4 v10, s[36:39], s68 offen nt lds
    s_addk_i32 m0, 0x1000
    s_xor_b32 s68, s66, 0x83000
    buffer_load_dwordx4 v10, s[36:39], s68 offen nt lds
    s_add_u32 s13, s12, 5
    s_and_b32 s13, s13, 7
    s_lshl_b32 s14, s13, 7
    s_add_u32 s14, s14, s64
    s_add_u32 s13, s12, 5
    s_and_b32 s13, s13, 7
    s_lshl_b32 s15, s13, 19
    s_add_u32 s15, s15, s65
    s_add_u32 m0, s67, 16384
    s_xor_b32 s68, s14, 0x0
    buffer_load_dwordx4 v8, s[32:35], s68 offen  lds
    s_addk_i32 m0, 0x1000
    s_xor_b32 s68, s14, 0x8000
    buffer_load_dwordx4 v8, s[32:35], s68 offen  lds
    s_addk_i32 m0, 0x1000
    s_xor_b32 s68, s14, 0x10000
    buffer_load_dwordx4 v8, s[32:35], s68 offen  lds
    s_addk_i32 m0, 0x1000
    s_xor_b32 s68, s14, 0x18000
    buffer_load_dwordx4 v8, s[32:35], s68 offen  lds
    s_add_u32 m0, s67, 81920
    s_add_u32 s68, s15, 0
    buffer_load_dwordx4 v9, s[44:47], s68 offen  lds
    s_addk_i32 m0, 0x1000
    s_add_u32 s68, s15, 131072
    buffer_load_dwordx4 v9, s[44:47], s68 offen  lds
    s_addk_i32 m0, 0x1000
    s_add_u32 s68, s15, 262144
    buffer_load_dwordx4 v9, s[44:47], s68 offen  lds
    s_addk_i32 m0, 0x1000
    s_add_u32 s68, s15, 393216
    buffer_load_dwordx4 v9, s[44:47], s68 offen  lds
    s_waitcnt vmcnt(12)
    s_barrier
    s_add_u32 s13, s12, 6
    s_and_b32 s13, s13, 7
    s_lshl_b32 s14, s13, 7
    s_add_u32 s14, s14, s64
    s_add_u32 s13, s12, 6
    s_and_b32 s13, s13, 7
    s_lshl_b32 s15, s13, 19
    s_add_u32 s15, s15, s65
    s_add_u32 m0, s67, 32768
    s_xor_b32 s68, s14, 0x0
    buffer_load_dwordx4 v8, s[32:35], s68 offen  lds
    s_addk_i32 m0, 0x1000
    s_xor_b32 s68, s14, 0x8000
    buffer_load_dwordx4 v8, s[32:35], s68 offen  lds
    s_addk_i32 m0, 0x1000
    s_xor_b32 s68, s14, 0x10000
    buffer_load_dwordx4 v8, s[32:35], s68 offen  lds
    s_addk_i32 m0, 0x1000
    s_xor_b32 s68, s14, 0x18000
    buffer_load_dwordx4 v8, s[32:35], s68 offen  lds
    s_add_u32 m0, s67, 98304
    s_add_u32 s68, s15, 0
    buffer_load_dwordx4 v9, s[44:47], s68 offen  lds
    s_addk_i32 m0, 0x1000
    s_add_u32 s68, s15, 131072
    buffer_load_dwordx4 v9, s[44:47], s68 offen  lds
    s_addk_i32 m0, 0x1000
    s_add_u32 s68, s15, 262144
    buffer_load_dwordx4 v9, s[44:47], s68 offen  lds
    s_addk_i32 m0, 0x1000
    s_add_u32 s68, s15, 393216
    buffer_load_dwordx4 v9, s[44:47], s68 offen  lds
    s_waitcnt vmcnt(8)
    s_barrier
    s_add_u32 s13, s12, 7
    s_and_b32 s13, s13, 7
    s_lshl_b32 s14, s13, 7
    s_add_u32 s14, s14, s64
    s_add_u32 s13, s12, 7
    s_and_b32 s13, s13, 7
    s_lshl_b32 s15, s13, 19
    s_add_u32 s15, s15, s65
    s_add_u32 m0, s67, 49152
    s_xor_b32 s68, s14, 0x0
    buffer_load_dwordx4 v8, s[32:35], s68 offen  lds
    s_addk_i32 m0, 0x1000
    s_xor_b32 s68, s14, 0x8000
    buffer_load_dwordx4 v8, s[32:35], s68 offen  lds
    s_addk_i32 m0, 0x1000
    s_xor_b32 s68, s14, 0x10000
    buffer_load_dwordx4 v8, s[32:35], s68 offen  lds
    s_addk_i32 m0, 0x1000
    s_xor_b32 s68, s14, 0x18000
    buffer_load_dwordx4 v8, s[32:35], s68 offen  lds
    s_add_u32 m0, s67, 114688
    s_add_u32 s68, s15, 0
    buffer_load_dwordx4 v9, s[44:47], s68 offen  lds
    s_addk_i32 m0, 0x1000
    s_add_u32 s68, s15, 131072
    buffer_load_dwordx4 v9, s[44:47], s68 offen  lds
    s_addk_i32 m0, 0x1000
    s_add_u32 s68, s15, 262144
    buffer_load_dwordx4 v9, s[44:47], s68 offen  lds
    s_addk_i32 m0, 0x1000
    s_add_u32 s68, s15, 393216
    buffer_load_dwordx4 v9, s[44:47], s68 offen  lds
    s_waitcnt vmcnt(8)
    s_barrier
    s_branch L_merge
L_hole0:
    s_branch L_holeg1
L_g1:
    s_add_u32 s13, s12, 3
    s_and_b32 s13, s13, 7
    s_lshl_b32 s14, s13, 7
    s_add_u32 s14, s14, s64
    s_add_u32 s13, s12, 3
    s_and_b32 s13, s13, 7
    s_lshl_b32 s15, s13, 19
    s_add_u32 s15, s15, s65
    s_add_u32 m0, s67, 49152
    s_xor_b32 s68, s14, 0x0
    buffer_load_dwordx4 v8, s[32:35], s68 offen  lds
    s_addk_i32 m0, 0x1000
    s_xor_b32 s68, s14, 0x8000
    buffer_load_dwordx4 v8, s[32:35], s68 offen  lds
    s_addk_i32 m0, 0x1000
    s_xor_b32 s68, s14, 0x10000
    buffer_load_dwordx4 v8, s[32:35], s68 offen  lds
    s_addk_i32 m0, 0x1000
    s_xor_b32 s68, s14, 0x18000
    buffer_load_dwordx4 v8, s[32:35], s68 offen  lds
    s_add_u32 m0, s67, 114688
    s_add_u32 s68, s15, 0
    buffer_load_dwordx4 v9, s[44:47], s68 offen  lds
    s_addk_i32 m0, 0x1000
    s_add_u32 s68, s15, 131072
    buffer_load_dwordx4 v9, s[44:47], s68 offen  lds
    s_addk_i32 m0, 0x1000
    s_add_u32 s68, s15, 262144
    buffer_load_dwordx4 v9, s[44:47], s68 offen  lds
    s_addk_i32 m0, 0x1000
    s_add_u32 s68, s15, 393216
    buffer_load_dwordx4 v9, s[44:47], s68 offen  lds
    s_waitcnt vmcnt(8)
    s_barrier
    s_cmp_lg_u32 s3, 0
    s_cbranch_scc1 L_k3
    s_waitcnt vmcnt(16)
    s_lshl_b32 s13, s72, 2
    v_mov_b32 v2, 1
    s_mov_b64 exec, 1
    buffer_atomic_add v2, v17, s[60:63], s13 offen
    s_mov_b64 exec, -1
L_k3:
    s_add_u32 m0, s67, 131072
    s_xor_b32 s68, s66, 0x0
    buffer_load_dwordx4 v10, s[36:39], s68 offen nt lds
    s_addk_i32 m0, 0x1000
    s_xor_b32 s68, s66, 0x1000
    buffer_load_dwordx4 v10, s[36:39], s68 offen nt lds
    s_addk_i32 m0, 0x1000
    s_xor_b32 s68, s66, 0x2000
    buffer_load_dwordx4 v10, s[36:39], s68 offen nt lds
    s_addk_i32 m0, 0x1000
    s_xor_b32 s68, s66, 0x3000
    buffer_load_dwordx4 v10, s[36:39], s68 offen nt lds
    s_add_u32 s13, s12, 4
    s_and_b32 s13, s13, 7
    s_lshl_b32 s14, s13, 7
    s_add_u32 s14, s14, s64
    s_add_u32 s13, s12, 4
    s_and_b32 s13, s13, 7
    s_lshl_b32 s15, s13, 19
    s_add_u32 s15, s15, s65
    s_add_u32 m0, s67, 0
    s_xor_b32 s68, s14, 0x0
    buffer_load_dwordx4 v8, s[32:35], s68 offen  lds
    s_addk_i32 m0, 0x1000
    s_xor_b32 s68, s14, 0x8000
    buffer_load_dwordx4 v8, s[32:35], s68 offen  lds
    s_addk_i32 m0, 0x1000
    s_xor_b32 s68, s14, 0x10000
    buffer_load_dwordx4 v8, s[32:35], s68 offen  lds
    s_addk_i32 m0, 0x1000
    s_xor_b32 s68, s14, 0x18000
    buffer_load_dwordx4 v8, s[32:35], s68 offen  lds
    s_add_u32 m0, s67, 65536
    s_add_u32 s68, s15, 0
    buffer_load_dwordx4 v9, s[44:47], s68 offen  lds
    s_addk_i32 m0, 0x1000
    s_add_u32 s68, s15, 131072
    buffer_load_dwordx4 v9, s[44:47], s68 offen  lds
    s_addk_i32 m0, 0x1000
    s_add_u32 s68, s15, 262144
    buffer_load_dwordx4 v9, s[44:47], s68 offen  lds
    s_addk_i32 m0, 0x1000
    s_add_u32 s68, s15, 393216
    buffer_load_dwordx4 v9, s[44:47], s68 offen  lds
    s_waitcnt vmcnt(12)
    s_barrier
    s_add_u32 s13, s12, 5
    s_and_b32 s13, s13, 7
    s_lshl_b32 s14, s13, 7
    s_add_u32 s14, s14, s64
    s_add_u32 s13, s12, 5
    s_and_b32 s13, s13, 7
    s_lshl_b32 s15, s13, 19
    s_add_u32 s15, s15, s65
    s_add_u32 m0, s67, 16384
    s_xor_b32 s68, s14, 0x0
    buffer_load_dwordx4 v8, s[32:35], s68 offen  lds
    s_addk_i32 m0, 0x1000
    s_xor_b32 s68, s14, 0x8000
    buffer_load_dwordx4 v8, s[32:35], s68 offen  lds
    s_addk_i32 m0, 0x1000
    s_xor_b32 s68, s14, 0x10000
    buffer_load_dwordx4 v8, s[32:35], s68 offen  lds
    s_addk_i32 m0, 0x1000
    s_xor_b32 s68, s14, 0x18000
    buffer_load_dwordx4 v8, s[32:35], s68 offen  lds
    s_add_u32 m0, s67, 81920
    s_add_u32 s68, s15, 0
    buffer_load_dwordx4 v9, s[44:47], s68 offen  lds
    s_addk_i32 m0, 0x1000
    s_add_u32 s68, s15, 131072
    buffer_load_dwordx4 v9, s[44:47], s68 offen  lds
    s_addk_i32 m0, 0x1000
    s_add_u32 s68, s15, 262144
    buffer_load_dwordx4 v9, s[44:47], s68 offen  lds
    s_addk_i32 m0, 0x1000
    s_add_u32 s68, s15, 393216
    buffer_load_dwordx4 v9, s[44:47], s68 offen  lds
    s_waitcnt vmcnt(8)
    s_barrier
    s_add_u32 m0, s67, 147456
    s_xor_b32 s68, s66, 0x80000
    buffer_load_dwordx4 v10, s[36:39], s68 offen nt lds
    s_addk_i32 m0, 0x1000
    s_xor_b32 s68, s66, 0x81000
    buffer_load_dwordx4 v10, s[36:39], s68 offen nt lds
    s_addk_i32 m0, 0x1000
    s_xor_b32 s68, s66, 0x82000
    buffer_load_dwordx4 v10, s[36:39], s68 offen nt lds
    s_addk_i32 m0, 0x1000
    s_xor_b32 s68, s66, 0x83000
    buffer_load_dwordx4 v10, s[36:39], s68 offen nt lds
    s_add_u32 s13, s12, 6
    s_and_b32 s13, s13, 7
    s_lshl_b32 s14, s13, 7
    s_add_u32 s14, s14, s64
    s_add_u32 s13, s12, 6
    s_and_b32 s13, s13, 7
    s_lshl_b32 s15, s13, 19
    s_add_u32 s15, s15, s65
    s_add_u32 m0, s67, 32768
    s_xor_b32 s68, s14, 0x0
    buffer_load_dwordx4 v8, s[32:35], s68 offen  lds
    s_addk_i32 m0, 0x1000
    s_xor_b32 s68, s14, 0x8000
    buffer_load_dwordx4 v8, s[32:35], s68 offen  lds
    s_addk_i32 m0, 0x1000
    s_xor_b32 s68, s14, 0x10000
    buffer_load_dwordx4 v8, s[32:35], s68 offen  lds
    s_addk_i32 m0, 0x1000
    s_xor_b32 s68, s14, 0x18000
    buffer_load_dwordx4 v8, s[32:35], s68 offen  lds
    s_add_u32 m0, s67, 98304
    s_add_u32 s68, s15, 0
    buffer_load_dwordx4 v9, s[44:47], s68 offen  lds
    s_addk_i32 m0, 0x1000
    s_add_u32 s68, s15, 131072
    buffer_load_dwordx4 v9, s[44:47], s68 offen  lds
    s_addk_i32 m0, 0x1000
    s_add_u32 s68, s15, 262144
    buffer_load_dwordx4 v9, s[44:47], s68 offen  lds
    s_addk_i32 m0, 0x1000
    s_add_u32 s68, s15, 393216
    buffer_load_dwordx4 v9, s[44:47], s68 offen  lds
    s_waitcnt vmcnt(12)
    s_barrier
    s_add_u32 s13, s12, 7
    s_and_b32 s13, s13, 7
    s_lshl_b32 s14, s13, 7
    s_add_u32 s14, s14, s64
    s_add_u32 s13, s12, 7
    s_and_b32 s13, s13, 7
    s_lshl_b32 s15, s13, 19
    s_add_u32 s15, s15, s65
    s_add_u32 m0, s67, 49152
    s_xor_b32 s68, s14, 0x0
    buffer_load_dwordx4 v8, s[32:35], s68 offen  lds
    s_addk_i32 m0, 0x1000
    s_xor_b32 s68, s14, 0x8000
    buffer_load_dwordx4 v8, s[32:35], s68 offen  lds
    s_addk_i32 m0, 0x1000
    s_xor_b32 s68, s14, 0x10000
    buffer_load_dwordx4 v8, s[32:35], s68 offen  lds
    s_addk_i32 m0, 0x1000
    s_xor_b32 s68, s14, 0x18000
    buffer_load_dwordx4 v8, s[32:35], s68 offen  lds
    s_add_u32 m0, s67, 114688
    s_add_u32 s68, s15, 0
    buffer_load_dwordx4 v9, s[44:47], s68 offen  lds
    s_addk_i32 m0, 0x1000
    s_add_u32 s68, s15, 131072
    buffer_load_dwordx4 v9, s[44:47], s68 offen  lds
    s_addk_i32 m0, 0x1000
    s_add_u32 s68, s15, 262144
    buffer_load_dwordx4 v9, s[44:47], s68 offen  lds
    s_addk_i32 m0, 0x1000
    s_add_u32 s68, s15, 393216
    buffer_load_dwordx4 v9, s[44:47], s68 offen  lds
    s_waitcnt vmcnt(8)
    s_barrier
    s_branch L_merge
L_holeg1:
    s_branch L_hole1
L_merge:
    s_add_u32 s13, s8, 0
    s_and_b32 s13, s13, 3
    s_xor_b32 s75, s71, 0
    s_lshl_b32 s13, s13, 14
    s_lshl_b32 s75, s75, 7
    s_add_u32 s14, s13, s75
    s_add_u32 s14, s14, s69
    s_add_u32 m0, s67, 0
    s_xor_b32 s68, s14, 0x0
    buffer_load_dwordx4 v11, s[40:43], s68 offen  lds
    s_addk_i32 m0, 0x1000
    s_xor_b32 s68, s14, 0x2000
    buffer_load_dwordx4 v11, s[40:43], s68 offen  lds
    s_addk_i32 m0, 0x1000
    s_xor_b32 s68, s14, 0x80000
    buffer_load_dwordx4 v11, s[40:43], s68 offen  lds
    s_addk_i32 m0, 0x1000
    s_xor_b32 s68, s14, 0x82000
    buffer_load_dwordx4 v11, s[40:43], s68 offen  lds
    s_add_u32 s13, s8, 0
    s_and_b32 s13, s13, 3
    s_xor_b32 s75, s71, 0
    s_lshl_b32 s13, s13, 17
    s_lshl_b32 s75, s75, 16
    s_add_u32 s15, s13, s75
    s_add_u32 s15, s15, s70
    s_add_u32 m0, s67, 65536
    s_add_u32 s68, s15, 0
    buffer_load_dwordx4 v12, s[48:51], s68 offen  lds
    s_addk_i32 m0, 0x1000
    s_add_u32 s68, s15, 16384
    buffer_load_dwordx4 v12, s[48:51], s68 offen  lds
    s_addk_i32 m0, 0x1000
    s_add_u32 s68, s15, 32768
    buffer_load_dwordx4 v12, s[48:51], s68 offen  lds
    s_addk_i32 m0, 0x1000
    s_add_u32 s68, s15, 49152
    buffer_load_dwordx4 v12, s[48:51], s68 offen  lds
    s_waitcnt vmcnt(8)
    s_barrier
    s_add_u32 s13, s8, 0
    s_and_b32 s13, s13, 3
    s_xor_b32 s75, s71, 1
    s_lshl_b32 s13, s13, 14
    s_lshl_b32 s75, s75, 7
    s_add_u32 s14, s13, s75
    s_add_u32 s14, s14, s69
    s_add_u32 m0, s67, 16384
    s_xor_b32 s68, s14, 0x0
    buffer_load_dwordx4 v11, s[40:43], s68 offen  lds
    s_addk_i32 m0, 0x1000
    s_xor_b32 s68, s14, 0x2000
    buffer_load_dwordx4 v11, s[40:43], s68 offen  lds
    s_addk_i32 m0, 0x1000
    s_xor_b32 s68, s14, 0x80000
    buffer_load_dwordx4 v11, s[40:43], s68 offen  lds
    s_addk_i32 m0, 0x1000
    s_xor_b32 s68, s14, 0x82000
    buffer_load_dwordx4 v11, s[40:43], s68 offen  lds
    s_add_u32 s13, s8, 0
    s_and_b32 s13, s13, 3
    s_xor_b32 s75, s71, 1
    s_lshl_b32 s13, s13, 17
    s_lshl_b32 s75, s75, 16
    s_add_u32 s15, s13, s75
    s_add_u32 s15, s15, s70
    s_add_u32 m0, s67, 81920
    s_add_u32 s68, s15, 0
    buffer_load_dwordx4 v12, s[48:51], s68 offen  lds
    s_addk_i32 m0, 0x1000
    s_add_u32 s68, s15, 16384
    buffer_load_dwordx4 v12, s[48:51], s68 offen  lds
    s_addk_i32 m0, 0x1000
    s_add_u32 s68, s15, 32768
    buffer_load_dwordx4 v12, s[48:51], s68 offen  lds
    s_addk_i32 m0, 0x1000
    s_add_u32 s68, s15, 49152
    buffer_load_dwordx4 v12, s[48:51], s68 offen  lds
    s_barrier
    buffer_load_dword v20, v19, s[60:63], 0 offen sc1
    s_add_u32 s13, s8, 1
    s_and_b32 s13, s13, 3
    s_xor_b32 s75, s71, 0
    s_lshl_b32 s13, s13, 17
    s_lshl_b32 s75, s75, 16
    s_add_u32 s15, s13, s75
    s_add_u32 s15, s15, s70
    s_add_u32 m0, s67, 98304
    s_add_u32 s68, s15, 0
    buffer_load_dwordx4 v12, s[48:51], s68 offen  lds
    s_addk_i32 m0, 0x1000
    s_add_u32 s68, s15, 16384
    buffer_load_dwordx4 v12, s[48:51], s68 offen  lds
    s_addk_i32 m0, 0x1000
    s_add_u32 s68, s15, 32768
    buffer_load_dwordx4 v12, s[48:51], s68 offen  lds
    s_addk_i32 m0, 0x1000
    s_add_u32 s68, s15, 49152
    buffer_load_dwordx4 v12, s[48:51], s68 offen  lds
    s_waitcnt vmcnt(13)
    s_barrier
    s_waitcnt vmcnt(4)
    v_cmp_gt_u32 vcc, 4, v20
    s_cbranch_vccz L_lr4
L_ll4:
    s_sleep 8
    buffer_load_dword v20, v19, s[60:63], 0 offen sc1
    s_add_u32 s76, s76, 1
    s_waitcnt vmcnt(0)
    s_cmp_ge_u32 s76, 262144
    s_cbranch_scc1 L_lr4
    v_cmp_gt_u32 vcc, 4, v20
    s_cbranch_vccnz L_ll4
L_lr4:
    s_barrier
    s_add_u32 s13, s8, 1
    s_and_b32 s13, s13, 3
    s_xor_b32 s75, s71, 0
    s_lshl_b32 s13, s13, 14
    s_lshl_b32 s75, s75, 7
    s_add_u32 s14, s13, s75
    s_add_u32 s14, s14, s69
    s_add_u32 m0, s67, 32768
    s_xor_b32 s68, s14, 0x0
    buffer_load_dwordx4 v11, s[40:43], s68 offen  lds
    s_addk_i32 m0, 0x1000
    s_xor_b32 s68, s14, 0x2000
    buffer_load_dwordx4 v11, s[40:43], s68 offen  lds
    s_addk_i32 m0, 0x1000
    s_xor_b32 s68, s14, 0x80000
    buffer_load_dwordx4 v11, s[40:43], s68 offen  lds
    s_addk_i32 m0, 0x1000
    s_xor_b32 s68, s14, 0x82000
    buffer_load_dwordx4 v11, s[40:43], s68 offen  lds
    s_add_u32 s13, s8, 1
    s_and_b32 s13, s13, 3
    s_xor_b32 s75, s71, 1
    s_lshl_b32 s13, s13, 14
    s_lshl_b32 s75, s75, 7
    s_add_u32 s14, s13, s75
    s_add_u32 s14, s14, s69
    s_add_u32 s13, s8, 1
    s_and_b32 s13, s13, 3
    s_xor_b32 s75, s71, 1
    s_lshl_b32 s13, s13, 17
    s_lshl_b32 s75, s75, 16
    s_add_u32 s15, s13, s75
    s_add_u32 s15, s15, s70
    s_add_u32 m0, s67, 131072
    s_xor_b32 s68, s14, 0x0
    buffer_load_dwordx4 v11, s[40:43], s68 offen  lds
    s_add_u32 m0, s67, 114688
    s_add_u32 s68, s15, 0
    buffer_load_dwordx4 v12, s[48:51], s68 offen  lds
    s_add_u32 m0, s67, 135168
    s_xor_b32 s68, s14, 0x2000
    buffer_load_dwordx4 v11, s[40:43], s68 offen  lds
    s_add_u32 m0, s67, 118784
    s_add_u32 s68, s15, 16384
    buffer_load_dwordx4 v12, s[48:51], s68 offen  lds
    s_add_u32 m0, s67, 139264
    s_xor_b32 s68, s14, 0x80000
    buffer_load_dwordx4 v11, s[40:43], s68 offen  lds
    s_add_u32 m0, s67, 122880
    s_add_u32 s68, s15, 32768
    buffer_load_dwordx4 v12, s[48:51], s68 offen  lds
    s_add_u32 m0, s67, 143360
    s_xor_b32 s68, s14, 0x82000
    buffer_load_dwordx4 v11, s[40:43], s68 offen  lds
    s_add_u32 m0, s67, 126976
    s_add_u32 s68, s15, 49152
    buffer_load_dwordx4 v12, s[48:51], s68 offen  lds
    s_waitcnt vmcnt(8)
    s_barrier
    s_lshl_b32 s14, s3, 13
    s_add_u32 s13, s79, s14
    s_add_u32 s13, s13, 128
    s_mov_b32 s97, 1
    s_atomic_add s97, s[30:31], s13
    s_add_u32 s13, s8, 2
    s_and_b32 s13, s13, 3
    s_xor_b32 s75, s71, 0
    s_lshl_b32 s13, s13, 14
    s_lshl_b32 s75, s75, 7
    s_add_u32 s14, s13, s75
    s_add_u32 s14, s14, s69
    s_add_u32 s13, s8, 2
    s_and_b32 s13, s13, 3
    s_xor_b32 s75, s71, 0
    s_lshl_b32 s13, s13, 17
    s_lshl_b32 s75, s75, 16
    s_add_u32 s15, s13, s75
    s_add_u32 s15, s15, s70
    s_add_u32 m0, s67, 147456
    s_xor_b32 s68, s14, 0x0
    buffer_load_dwordx4 v11, s[40:43], s68 offen  lds
    s_add_u32 m0, s67, 65536
    s_add_u32 s68, s15, 0
    buffer_load_dwordx4 v12, s[48:51], s68 offen  lds
    s_add_u32 m0, s67, 151552
    s_xor_b32 s68, s14, 0x2000
    buffer_load_dwordx4 v11, s[40:43], s68 offen  lds
    s_add_u32 m0, s67, 69632
    s_add_u32 s68, s15, 16384
    buffer_load_dwordx4 v12, s[48:51], s68 offen  lds
    s_add_u32 m0, s67, 155648
    s_xor_b32 s68, s14, 0x80000
    buffer_load_dwordx4 v11, s[40:43], s68 offen  lds
    s_add_u32 m0, s67, 73728
    s_add_u32 s68, s15, 32768
    buffer_load_dwordx4 v12, s[48:51], s68 offen  lds
    s_add_u32 m0, s67, 159744
    s_xor_b32 s68, s14, 0x82000
    buffer_load_dwordx4 v11, s[40:43], s68 offen  lds
    s_add_u32 m0, s67, 77824
    s_add_u32 s68, s15, 49152
    buffer_load_dwordx4 v12, s[48:51], s68 offen  lds
    s_waitcnt vmcnt(8)
    s_barrier
    s_add_u32 s13, s8, 2
    s_and_b32 s13, s13, 3
    s_xor_b32 s75, s71, 1
    s_lshl_b32 s13, s13, 14
    s_lshl_b32 s75, s75, 7
    s_add_u32 s14, s13, s75
    s_add_u32 s14, s14, s69
    s_add_u32 s13, s8, 2
    s_and_b32 s13, s13, 3
    s_xor_b32 s75, s71, 1
    s_lshl_b32 s13, s13, 17
    s_lshl_b32 s75, s75, 16
    s_add_u32 s15, s13, s75
    s_add_u32 s15, s15, s70
    s_add_u32 m0, s67, 0
    s_xor_b32 s68, s14, 0x0
    buffer_load_dwordx4 v11, s[40:43], s68 offen  lds
    s_add_u32 m0, s67, 81920
    s_add_u32 s68, s15, 0
    buffer_load_dwordx4 v12, s[48:51], s68 offen  lds
    s_add_u32 m0, s67, 4096
    s_xor_b32 s68, s14, 0x2000
    buffer_load_dwordx4 v11, s[40:43], s68 offen  lds
    s_add_u32 m0, s67, 86016
    s_add_u32 s68, s15, 16384
    buffer_load_dwordx4 v12, s[48:51], s68 offen  lds
    s_add_u32 m0, s67, 8192
    s_xor_b32 s68, s14, 0x80000
    buffer_load_dwordx4 v11, s[40:43], s68 offen  lds
    s_add_u32 m0, s67, 90112
    s_add_u32 s68, s15, 32768
    buffer_load_dwordx4 v12, s[48:51], s68 offen  lds
    s_add_u32 m0, s67, 12288
    s_xor_b32 s68, s14, 0x82000
    buffer_load_dwordx4 v11, s[40:43], s68 offen  lds
    s_add_u32 m0, s67, 94208
    s_add_u32 s68, s15, 49152
    buffer_load_dwordx4 v12, s[48:51], s68 offen  lds
    s_waitcnt vmcnt(8)
    s_barrier
    s_add_u32 s13, s8, 3
    s_and_b32 s13, s13, 3
    s_xor_b32 s75, s71, 0
    s_lshl_b32 s13, s13, 14
    s_lshl_b32 s75, s75, 7
    s_add_u32 s14, s13, s75
    s_add_u32 s14, s14, s69
    s_add_u32 s13, s8, 3
    s_and_b32 s13, s13, 3
    s_xor_b32 s75, s71, 0
    s_lshl_b32 s13, s13, 17
    s_lshl_b32 s75, s75, 16
    s_add_u32 s15, s13, s75
    s_add_u32 s15, s15, s70
    s_add_u32 m0, s67, 16384
    s_xor_b32 s68, s14, 0x0
    buffer_load_dwordx4 v11, s[40:43], s68 offen  lds
    s_add_u32 m0, s67, 98304
    s_add_u32 s68, s15, 0
    buffer_load_dwordx4 v12, s[48:51], s68 offen  lds
    s_add_u32 m0, s67, 20480
    s_xor_b32 s68, s14, 0x2000
    buffer_load_dwordx4 v11, s[40:43], s68 offen  lds
    s_add_u32 m0, s67, 102400
    s_add_u32 s68, s15, 16384
    buffer_load_dwordx4 v12, s[48:51], s68 offen  lds
    s_add_u32 m0, s67, 24576
    s_xor_b32 s68, s14, 0x80000
    buffer_load_dwordx4 v11, s[40:43], s68 offen  lds
    s_add_u32 m0, s67, 106496
    s_add_u32 s68, s15, 32768
    buffer_load_dwordx4 v12, s[48:51], s68 offen  lds
    s_add_u32 m0, s67, 28672
    s_xor_b32 s68, s14, 0x82000
    buffer_load_dwordx4 v11, s[40:43], s68 offen  lds
    s_add_u32 m0, s67, 110592
    s_add_u32 s68, s15, 49152
    buffer_load_dwordx4 v12, s[48:51], s68 offen  lds
    s_waitcnt vmcnt(8)
    s_barrier
    s_add_u32 s78, s77, 128
    s_load_dword s80, s[30:31], s78 glc
    s_add_u32 s13, s8, 3
    s_and_b32 s13, s13, 3
    s_xor_b32 s75, s71, 1
    s_lshl_b32 s13, s13, 14
    s_lshl_b32 s75, s75, 7
    s_add_u32 s14, s13, s75
    s_add_u32 s14, s14, s69
    s_add_u32 s13, s8, 3
    s_and_b32 s13, s13, 3
    s_xor_b32 s75, s71, 1
    s_lshl_b32 s13, s13, 17
    s_lshl_b32 s75, s75, 16
    s_add_u32 s15, s13, s75
    s_add_u32 s15, s15, s70
    s_add_u32 m0, s67, 32768
    s_xor_b32 s68, s14, 0x0
    buffer_load_dwordx4 v11, s[40:43], s68 offen  lds
    s_add_u32 m0, s67, 114688
    s_add_u32 s68, s15, 0
    buffer_load_dwordx4 v12, s[48:51], s68 offen  lds
    s_add_u32 m0, s67, 36864
    s_xor_b32 s68, s14, 0x2000
    buffer_load_dwordx4 v11, s[40:43], s68 offen  lds
    s_add_u32 m0, s67, 118784
    s_add_u32 s68, s15, 16384
    buffer_load_dwordx4 v12, s[48:51], s68 offen  lds
    s_add_u32 m0, s67, 40960
    s_xor_b32 s68, s14, 0x80000
    buffer_load_dwordx4 v11, s[40:43], s68 offen  lds
    s_add_u32 m0, s67, 122880
    s_add_u32 s68, s15, 32768
    buffer_load_dwordx4 v12, s[48:51], s68 offen  lds
    s_add_u32 m0, s67, 45056
    s_xor_b32 s68, s14, 0x82000
    buffer_load_dwordx4 v11, s[40:43], s68 offen  lds
    s_add_u32 m0, s67, 126976
    s_add_u32 s68, s15, 49152
    buffer_load_dwordx4 v12, s[48:51], s68 offen  lds
    s_waitcnt vmcnt(8)
    s_barrier
    s_waitcnt lgkmcnt(0)
    s_cmp_ge_u32 s80, 4
    s_cbranch_scc1 L_lr5
L_ll5:
    s_load_dword s80, s[30:31], s78 glc
    s_add_u32 s76, s76, 1
    s_waitcnt lgkmcnt(0)
    s_cmp_ge_u32 s76, 262144
    s_cbranch_scc1 L_lr5
    s_cmp_lt_u32 s80, 4
    s_cbranch_scc1 L_ll5
L_lr5:
    s_add_u32 s13, s8, 1
    s_and_b32 s13, s13, 3
    s_lshl_b32 s13, s13, 14
    s_add_u32 s15, s13, s73
    s_add_u32 s15, s15, s67
    s_add_u32 m0, s67, 131072
    s_add_u32 s68, s15, 0
    buffer_load_dwordx4 v13, s[56:59], s68 offen sc1 lds
    s_addk_i32 m0, 0x1000
    s_add_u32 s68, s15, 4096
    buffer_load_dwordx4 v13, s[56:59], s68 offen sc1 lds
    s_add_u32 s13, s8, 2
    s_and_b32 s13, s13, 3
    s_lshl_b32 s13, s13, 14
    s_add_u32 s15, s13, s73
    s_add_u32 s15, s15, s67
    s_add_u32 m0, s67, 147456
    s_add_u32 s68, s15, 0
    buffer_load_dwordx4 v13, s[56:59], s68 offen sc1 lds
    s_addk_i32 m0, 0x1000
    s_add_u32 s68, s15, 4096
    buffer_load_dwordx4 v13, s[56:59], s68 offen sc1 lds
    s_add_u32 s13, s8, 3
    s_and_b32 s13, s13, 3
    s_lshl_b32 s13, s13, 14
    s_add_u32 s15, s13, s73
    s_add_u32 s15, s15, s67
    s_add_u32 m0, s67, 65536
    s_add_u32 s68, s15, 0
    buffer_load_dwordx4 v13, s[56:59], s68 offen sc1 lds
    s_addk_i32 m0, 0x1000
    s_add_u32 s68, s15, 4096
    buffer_load_dwordx4 v13, s[56:59], s68 offen sc1 lds
    s_waitcnt vmcnt(6)
    s_barrier
    s_add_u32 s13, s8, 1
    s_and_b32 s13, s13, 3
    s_lshl_b32 s13, s13, 14
    s_add_u32 s15, s13, s73
    s_add_u32 s15, s15, s67
    s_add_u32 m0, s67, 139264
    s_add_u32 s68, s15, 8192
    buffer_load_dwordx4 v13, s[56:59], s68 offen sc1 lds
    s_addk_i32 m0, 0x1000
    s_add_u32 s68, s15, 12288
    buffer_load_dwordx4 v13, s[56:59], s68 offen sc1 lds
    s_add_u32 s13, s8, 2
    s_and_b32 s13, s13, 3
    s_lshl_b32 s13, s13, 14
    s_add_u32 s15, s13, s73
    s_add_u32 s15, s15, s67
    s_add_u32 m0, s67, 155648
    s_add_u32 s68, s15, 8192
    buffer_load_dwordx4 v13, s[56:59], s68 offen sc1 lds
    s_addk_i32 m0, 0x1000
    s_add_u32 s68, s15, 12288
    buffer_load_dwordx4 v13, s[56:59], s68 offen sc1 lds
    s_add_u32 s13, s8, 3
    s_and_b32 s13, s13, 3
    s_lshl_b32 s13, s13, 14
    s_add_u32 s15, s13, s73
    s_add_u32 s15, s15, s67
    s_add_u32 m0, s67, 73728
    s_add_u32 s68, s15, 8192
    buffer_load_dwordx4 v13, s[56:59], s68 offen sc1 lds
    s_addk_i32 m0, 0x1000
    s_add_u32 s68, s15, 12288
    buffer_load_dwordx4 v13, s[56:59], s68 offen sc1 lds
    s_waitcnt vmcnt(6)
    s_barrier
    s_waitcnt vmcnt(0)
    s_barrier
    s_lshl_b32 s13, s11, 2
    s_add_u32 s13, s13, s9
    s_lshl_b32 s13, s13, 3
    s_add_u32 s13, s13, s4
    s_lshl_b32 s14, s13, 2
    s_add_u32 s14, s14, s3
    s_lshl_b32 s14, s14, 13
    s_add_u32 s14, s14, 8388608
    s_lshl1_add_u32 s15, s9, s11
    s_and_b32 s15, s15, 7
    s_lshl_b32 s15, s15, 10
    s_add_u32 s14, s14, s15
    s_lshl_b32 s75, s3, 8
    s_add_u32 s13, s77, s75
    s_lshl_b32 s75, s3, 6
    s_lshl_b32 s77, s9, 8
    s_add_u32 s75, s75, s77
    s_lshl_b32 s76, s72, 4
    v_add_u32 v1, s76, v4
    v_lshlrev_b32 v1, 10, v1
    v_bfe_u32 v2, v0, 4, 1
    v_lshl_add_u32 v1, v2, 5, v1
    v_lshrrev_b32 v2, 5, v0
    v_lshl_add_u32 v1, v2, 4, v1
    v_add_u32 v1, s75, v1
    v_add_u32 v14, 114688, v14
    s_mov_b32 s76, 0
    s_xor_b32 s88, s14, 0
    s_xor_b32 s89, s14, 1024
    s_xor_b32 s90, s14, 2048
    s_xor_b32 s91, s14, 3072
    s_xor_b32 s92, s14, 4096
    s_xor_b32 s93, s14, 5120
    s_xor_b32 s94, s14, 6144
    v_bfe_u32 v2, v0, 2, 2
    v_lshrrev_b32 v3, 4, v0
    v_and_b32 v5, 1, v0
    v_lshlrev_b32 v5, 4, v5
    v_mov_b32 v6, 0x3f80
    v_lshlrev_b32 v5, v5, v6
    v_cmp_eq_u32 vcc, v2, v3
    v_bfe_u32 v6, v0, 1, 1
    v_mov_b32 v98, 0
    v_cndmask_b32 v5, 0, v5, vcc
    v_cmp_eq_u32 vcc, 0, v6
    v_mov_b32 v99, 0
    v_mov_b32 v100, 0
    v_cndmask_b32 v96, 0, v5, vcc
    v_mov_b32 v101, 0
    v_sub_u32 v97, v5, v96
    v_mov_b32 v102, v96
    v_mov_b32 v103, v97
    s_mov_b64 vcc, -1
    s_branch L_tp0
L_tb:
    s_mov_b64 vcc, 0
L_fw0:
    s_load_dwordx8 s[80:87], s[30:31], s13 glc
    s_add_u32 s76, s76, 1
    s_cmp_ge_u32 s76, 262144
    s_waitcnt lgkmcnt(0)
    s_cbranch_scc1 L_fd0
    s_cmp_eq_u32 s80, 0
    s_cbranch_scc1 L_fw0
L_fd0:
    buffer_load_dwordx4 v[64:67], v13, s[56:59], s88 offen sc1
    s_cmp_lg_u32 s81, 0
    s_cbranch_scc1 L_fd1
L_fw1:
    s_load_dwordx8 s[80:87], s[30:31], s13 glc
    s_add_u32 s76, s76, 1
    s_cmp_ge_u32 s76, 262144
    s_waitcnt lgkmcnt(0)
    s_cbranch_scc1 L_fd1
    s_cmp_eq_u32 s81, 0
    s_cbranch_scc1 L_fw1
L_fd1:
    buffer_load_dwordx4 v[68:71], v13, s[56:59], s89 offen sc1
    s_cmp_lg_u32 s82, 0
    s_cbranch_scc1 L_fd2
L_fw2:
    s_load_dwordx8 s[80:87], s[30:31], s13 glc
    s_add_u32 s76, s76, 1
    s_cmp_ge_u32 s76, 262144
    s_waitcnt lgkmcnt(0)
    s_cbranch_scc1 L_fd2
    s_cmp_eq_u32 s82, 0
    s_cbranch_scc1 L_fw2
L_fd2:
    buffer_load_dwordx4 v[72:75], v13, s[56:59], s90 offen sc1
L_tp0:
    s_cbranch_vccnz L_tp1
    s_cmp_lg_u32 s83, 0
    s_cbranch_scc1 L_fd3
L_fw3:
    s_load_dwordx8 s[80:87], s[30:31], s13 glc
    s_add_u32 s76, s76, 1
    s_cmp_ge_u32 s76, 262144
    s_waitcnt lgkmcnt(0)
    s_cbranch_scc1 L_fd3
    s_cmp_eq_u32 s83, 0
    s_cbranch_scc1 L_fw3
L_fd3:
    buffer_load_dwordx4 v[76:79], v13, s[56:59], s91 offen sc1
    s_cmp_lg_u32 s84, 0
    s_cbranch_scc1 L_fd4
L_fw4:
    s_load_dwordx8 s[80:87], s[30:31], s13 glc
    s_add_u32 s76, s76, 1
    s_cmp_ge_u32 s76, 262144
    s_waitcnt lgkmcnt(0)
    s_cbranch_scc1 L_fd4
    s_cmp_eq_u32 s84, 0
    s_cbranch_scc1 L_fw4
L_fd4:
    buffer_load_dwordx4 v[80:83], v13, s[56:59], s92 offen sc1
    s_cmp_lg_u32 s85, 0
    s_cbranch_scc1 L_fd5
L_fw5:
    s_load_dwordx8 s[80:87], s[30:31], s13 glc
    s_add_u32 s76, s76, 1
    s_cmp_ge_u32 s76, 262144
    s_waitcnt lgkmcnt(0)
    s_cbranch_scc1 L_fd5
    s_cmp_eq_u32 s85, 0
    s_cbranch_scc1 L_fw5
L_fd5:
    buffer_load_dwordx4 v[84:87], v13, s[56:59], s93 offen sc1
    s_cmp_lg_u32 s86, 0
    s_cbranch_scc1 L_fd6
L_fw6:
    s_load_dwordx8 s[80:87], s[30:31], s13 glc
    s_add_u32 s76, s76, 1
    s_cmp_ge_u32 s76, 262144
    s_waitcnt lgkmcnt(0)
    s_cbranch_scc1 L_fd6
    s_cmp_eq_u32 s86, 0
    s_cbranch_scc1 L_fw6
L_fd6:
    buffer_load_dwordx4 v[88:91], v13, s[56:59], s94 offen sc1
L_tp1:
    s_cbranch_vccnz L_tp2
    s_barrier
    ds_read_b128 v[40:43], v14
    ds_read_b128 v[44:47], v14 offset:1024
    s_waitcnt lgkmcnt(0)
    s_waitcnt vmcnt(6)
    v_mfma_f32_16x16x32_bf16 v[40:43], v[96:99], v[64:67], v[40:43]
    v_mfma_f32_16x16x32_bf16 v[44:47], v[100:103], v[64:67], v[44:47]
    s_waitcnt vmcnt(5)
    v_mfma_f32_16x16x32_bf16 v[40:43], v[96:99], v[68:71], v[40:43]
    v_mfma_f32_16x16x32_bf16 v[44:47], v[100:103], v[68:71], v[44:47]
    s_waitcnt vmcnt(4)
    v_mfma_f32_16x16x32_bf16 v[40:43], v[96:99], v[72:75], v[40:43]
    v_mfma_f32_16x16x32_bf16 v[44:47], v[100:103], v[72:75], v[44:47]
    s_waitcnt vmcnt(3)
    v_mfma_f32_16x16x32_bf16 v[40:43], v[96:99], v[76:79], v[40:43]
    v_mfma_f32_16x16x32_bf16 v[44:47], v[100:103], v[76:79], v[44:47]
    s_waitcnt vmcnt(2)
    v_mfma_f32_16x16x32_bf16 v[40:43], v[96:99], v[80:83], v[40:43]
    v_mfma_f32_16x16x32_bf16 v[44:47], v[100:103], v[80:83], v[44:47]
    s_waitcnt vmcnt(1)
    v_mfma_f32_16x16x32_bf16 v[40:43], v[96:99], v[84:87], v[40:43]
    v_mfma_f32_16x16x32_bf16 v[44:47], v[100:103], v[84:87], v[44:47]
    s_waitcnt vmcnt(0)
    v_mfma_f32_16x16x32_bf16 v[40:43], v[96:99], v[88:91], v[40:43]
    v_mfma_f32_16x16x32_bf16 v[44:47], v[100:103], v[88:91], v[44:47]
L_tp2:
    s_cbranch_vccnz L_tp3
    s_nop 5
    v_cvt_pk_bf16_f32 v56, v40, v41
    v_cvt_pk_bf16_f32 v57, v42, v43
    v_cvt_pk_bf16_f32 v58, v44, v45
    v_cvt_pk_bf16_f32 v59, v46, v47
    s_nop 1
    v_permlane16_swap_b32 v56, v58
    v_permlane16_swap_b32 v57, v59
    buffer_store_dwordx4 v[56:59], v1, s[52:55], 0 offen sc1
    s_endpgm
L_tp3:
    s_branch L_tb
L_hole1:
    s_branch L_pad0
.p2align 12
L_compute:
    s_mov_b32 s58, 0x10000000
    s_mov_b32 s59, 0x20000
    v_and_b32 v1, 15, v0
    v_lshrrev_b32 v2, 4, v0
    v_bfe_u32 v3, v0, 1, 3
    v_xor_b32 v3, v3, v2
    v_lshlrev_b32 v3, 4, v3
    v_lshl_add_u32 v3, v1, 7, v3
    s_lshl_b32 s70, s3, 12
    v_add_u32 v4, s70, v3
    v_xor_b32 v5, 64, v4
    v_add_u32 v6, 0x20000, v3
    v_xor_b32 v7, 64, v6
    v_lshrrev_b32 v3, 1, v2
    v_xor_b32 v3, v3, v1
    v_lshlrev_b32 v3, 4, v3
    v_lshl_add_u32 v3, v1, 8, v3
    v_and_b32 v18, 1, v2
    v_lshl_add_u32 v3, v18, 3, v3
    s_lshr_b32 s13, s3, 1
    s_lshl_b32 s13, s13, 14
    s_add_u32 s13, s13, 0x20000
    v_add_u32 v160, s13, v3
    v_lshlrev_b32 v16, 4, v0
    v_add_u32 v17, s70, v16
    v_bfe_u32 v1, v0, 2, 2
    v_and_b32 v3, 3, v0
    v_lshlrev_b32 v3, 3, v3
    v_lshl_add_u32 v19, v18, 2, v1
    v_lshl_add_u32 v20, v2, 3, v1
    v_lshlrev_b32 v20, 8, v20
    v_lshl_add_u32 v20, v19, 5, v20
    v_add_u32 v20, v20, v3
    v_add_u32 v8, 0x10000, v20
    v_xor_b32 v9, 32, v8
    v_xor_b32 v161, 32, v160
    v_xor_b32 v10, 64, v8
    v_xor_b32 v162, 64, v160
    v_xor_b32 v11, 96, v8
    v_xor_b32 v163, 96, v160
    v_xor_b32 v12, 128, v8
    v_xor_b32 v164, 128, v160
    v_xor_b32 v13, 160, v8
    v_xor_b32 v165, 160, v160
    v_xor_b32 v14, 192, v8
    v_xor_b32 v166, 192, v160
    v_xor_b32 v15, 224, v8
    v_xor_b32 v167, 224, v160
    s_lshl2_add_u32 s13, s11, s9
    s_lshl3_add_u32 s13, s13, s4
    s_lshl2_add_u32 s13, s13, s3
    s_lshl_b32 s65, s13, 13
    s_lshl_b32 s66, s13, 8
    s_lshl1_add_u32 s14, s9, s11
    s_and_b32 s14, s14, 7
    s_lshl_b32 s14, s14, 10
    s_add_u32 s65, s65, s14
    s_xor_b32 s80, s65, 0x838000
    s_xor_b32 s72, s66, 0x401c00
    s_xor_b32 s81, s65, 0x830400
    s_xor_b32 s73, s66, 0x401804
    s_xor_b32 s82, s65, 0x828800
    s_xor_b32 s74, s66, 0x401408
    s_xor_b32 s83, s65, 0x820c00
    s_xor_b32 s75, s66, 0x40100c
    s_xor_b32 s84, s65, 0x819000
    s_xor_b32 s76, s66, 0x400c10
    s_xor_b32 s85, s65, 0x811400
    s_xor_b32 s77, s66, 0x400814
    s_xor_b32 s86, s65, 0x809800
    s_xor_b32 s78, s66, 0x400418
    s_lshl3_add_u32 s13, s11, s4
    s_lshl2_add_u32 s13, s13, s8
    s_lshl_b32 s64, s13, 14
    s_mov_b32 s68, 0x3e0293ee
    s_mov_b32 s69, 0x3e0293ee
    s_lshl_b32 s71, s3, 6
    s_mov_b32 s87, 1
    s_waitcnt lgkmcnt(0)
    s_mov_b64 s[56:57], s[30:31]
    s_waitcnt vmcnt(0)
    s_mov_b64 vcc, -1
    s_branch L_hole0
L_back:
    s_mov_b64 vcc, 0
    s_barrier
    ds_read_b128 v[112:115], v4 offset:0
    ds_read_b128 v[116:119], v4 offset:2048
    ds_read_b64_tr_b16 v[88:89], v8 offset:0
    ds_read_b64_tr_b16 v[90:91], v12 offset:1024
    ds_read_b64_tr_b16 v[92:93], v9 offset:0
    ds_read_b64_tr_b16 v[94:95], v13 offset:1024
    ds_read_b64_tr_b16 v[96:97], v10 offset:0
    ds_read_b64_tr_b16 v[98:99], v14 offset:1024
    ds_read_b64_tr_b16 v[100:101], v11 offset:0
    ds_read_b64_tr_b16 v[102:103], v15 offset:1024
    ds_read_b64_tr_b16 v[104:105], v12 offset:0
    ds_read_b64_tr_b16 v[106:107], v8 offset:1024
    ds_read_b64_tr_b16 v[108:109], v13 offset:0
    ds_read_b64_tr_b16 v[110:111], v9 offset:1024
    s_waitcnt lgkmcnt(10)
    v_mfma_f32_16x16x32_bf16 v[24:27], v[88:91], v[112:115], 0
    v_mfma_f32_16x16x32_bf16 v[28:31], v[88:91], v[116:119], 0
    ds_read_b64_tr_b16 v[88:89], v14 offset:0
    s_waitcnt lgkmcnt(9)
    v_mfma_f32_16x16x32_bf16 v[36:39], v[92:95], v[116:119], 0
    ds_read_b64_tr_b16 v[90:91], v10 offset:1024
    v_mfma_f32_16x16x32_bf16 v[32:35], v[92:95], v[112:115], 0
    ds_read_b64_tr_b16 v[92:93], v15 offset:0
    s_waitcnt lgkmcnt(7)
    v_mfma_f32_16x16x32_bf16 v[40:43], v[96:99], v[112:115], 0
    ds_read_b64_tr_b16 v[94:95], v11 offset:1024
    ds_read_b128 v[120:123], v5 offset:0
    v_mfma_f32_16x16x32_bf16 v[44:47], v[96:99], v[116:119], 0
    ds_read_b64_tr_b16 v[96:97], v8 offset:8192
    v_mfma_f32_16x16x32_bf16 v[52:55], v[100:103], v[116:119], 0
    ds_read_b64_tr_b16 v[98:99], v12 offset:9216
    v_mfma_f32_16x16x32_bf16 v[48:51], v[100:103], v[112:115], 0
    ds_read_b64_tr_b16 v[100:101], v9 offset:8192
    s_waitcnt lgkmcnt(8)
    v_mfma_f32_16x16x32_bf16 v[56:59], v[104:107], v[112:115], 0
    ds_read_b64_tr_b16 v[102:103], v13 offset:9216
    ds_read_b128 v[124:127], v5 offset:2048
    v_mfma_f32_16x16x32_bf16 v[60:63], v[104:107], v[116:119], 0
    ds_read_b64_tr_b16 v[104:105], v10 offset:8192
    v_mfma_f32_16x16x32_bf16 v[68:71], v[108:111], v[116:119], 0
    ds_read_b64_tr_b16 v[106:107], v14 offset:9216
    v_mfma_f32_16x16x32_bf16 v[64:67], v[108:111], v[112:115], 0
    ds_read_b64_tr_b16 v[108:109], v11 offset:8192
    s_waitcnt lgkmcnt(9)
    v_mfma_f32_16x16x32_bf16 v[72:75], v[88:91], v[112:115], 0
    ds_read_b64_tr_b16 v[110:111], v15 offset:9216
    v_mfma_f32_16x16x32_bf16 v[76:79], v[88:91], v[116:119], 0
    ds_read_b64_tr_b16 v[88:89], v12 offset:8192
    v_mfma_f32_16x16x32_bf16 v[84:87], v[92:95], v[116:119], 0
    ds_read_b64_tr_b16 v[90:91], v8 offset:9216
    v_mfma_f32_16x16x32_bf16 v[80:83], v[92:95], v[112:115], 0
    ds_read_b64_tr_b16 v[92:93], v13 offset:8192
    s_waitcnt lgkmcnt(8)
    v_mfma_f32_16x16x32_bf16 v[24:27], v[96:99], v[120:123], v[24:27]
    ds_read_b64_tr_b16 v[94:95], v9 offset:9216
    s_waitcnt lgkmcnt(8)
    v_mfma_f32_16x16x32_bf16 v[28:31], v[96:99], v[124:127], v[28:31]
    ds_read_b64_tr_b16 v[96:97], v14 offset:8192
    v_mfma_f32_16x16x32_bf16 v[36:39], v[100:103], v[124:127], v[36:39]
    ds_read_b64_tr_b16 v[98:99], v10 offset:9216
    v_mfma_f32_16x16x32_bf16 v[32:35], v[100:103], v[120:123], v[32:35]
    ds_read_b64_tr_b16 v[100:101], v15 offset:8192
    s_barrier
    s_waitcnt lgkmcnt(7)
    v_mfma_f32_16x16x32_bf16 v[40:43], v[104:107], v[120:123], v[40:43]
    ds_read_b64_tr_b16 v[102:103], v11 offset:9216
    ds_read_b128 v[112:115], v4 offset:16384
    v_mfma_f32_16x16x32_bf16 v[44:47], v[104:107], v[124:127], v[44:47]
    ds_read_b64_tr_b16 v[104:105], v8 offset:16384
    v_mfma_f32_16x16x32_bf16 v[52:55], v[108:111], v[124:127], v[52:55]
    ds_read_b64_tr_b16 v[106:107], v12 offset:17408
    v_mfma_f32_16x16x32_bf16 v[48:51], v[108:111], v[120:123], v[48:51]
    ds_read_b64_tr_b16 v[108:109], v9 offset:16384
    s_waitcnt lgkmcnt(8)
    v_mfma_f32_16x16x32_bf16 v[56:59], v[88:91], v[120:123], v[56:59]
    ds_read_b64_tr_b16 v[110:111], v13 offset:17408
    ds_read_b128 v[116:119], v4 offset:18432
    v_mfma_f32_16x16x32_bf16 v[60:63], v[88:91], v[124:127], v[60:63]
    ds_read_b64_tr_b16 v[88:89], v10 offset:16384
    v_mfma_f32_16x16x32_bf16 v[68:71], v[92:95], v[124:127], v[68:71]
    ds_read_b64_tr_b16 v[90:91], v14 offset:17408
    v_mfma_f32_16x16x32_bf16 v[64:67], v[92:95], v[120:123], v[64:67]
    ds_read_b64_tr_b16 v[92:93], v11 offset:16384
    s_waitcnt lgkmcnt(9)
    v_mfma_f32_16x16x32_bf16 v[72:75], v[96:99], v[120:123], v[72:75]
    ds_read_b64_tr_b16 v[94:95], v15 offset:17408
    v_mfma_f32_16x16x32_bf16 v[76:79], v[96:99], v[124:127], v[76:79]
    ds_read_b64_tr_b16 v[96:97], v12 offset:16384
    v_mfma_f32_16x16x32_bf16 v[84:87], v[100:103], v[124:127], v[84:87]
    ds_read_b64_tr_b16 v[98:99], v8 offset:17408
    v_mfma_f32_16x16x32_bf16 v[80:83], v[100:103], v[120:123], v[80:83]
    ds_read_b64_tr_b16 v[100:101], v13 offset:16384
    s_waitcnt lgkmcnt(8)
    v_mfma_f32_16x16x32_bf16 v[24:27], v[104:107], v[112:115], v[24:27]
    ds_read_b64_tr_b16 v[102:103], v9 offset:17408
    s_waitcnt lgkmcnt(8)
    v_mfma_f32_16x16x32_bf16 v[28:31], v[104:107], v[116:119], v[28:31]
    ds_read_b64_tr_b16 v[104:105], v14 offset:16384
    v_mfma_f32_16x16x32_bf16 v[36:39], v[108:111], v[116:119], v[36:39]
    ds_read_b64_tr_b16 v[106:107], v10 offset:17408
    v_mfma_f32_16x16x32_bf16 v[32:35], v[108:111], v[112:115], v[32:35]
    ds_read_b64_tr_b16 v[108:109], v15 offset:16384
    s_waitcnt lgkmcnt(7)
    v_mfma_f32_16x16x32_bf16 v[40:43], v[88:91], v[112:115], v[40:43]
    ds_read_b64_tr_b16 v[110:111], v11 offset:17408
    ds_read_b128 v[120:123], v5 offset:16384
    v_mfma_f32_16x16x32_bf16 v[44:47], v[88:91], v[116:119], v[44:47]
    ds_read_b64_tr_b16 v[88:89], v8 offset:24576
    v_mfma_f32_16x16x32_bf16 v[52:55], v[92:95], v[116:119], v[52:55]
    ds_read_b64_tr_b16 v[90:91], v12 offset:25600
    v_mfma_f32_16x16x32_bf16 v[48:51], v[92:95], v[112:115], v[48:51]
    ds_read_b64_tr_b16 v[92:93], v9 offset:24576
    s_waitcnt lgkmcnt(8)
    v_mfma_f32_16x16x32_bf16 v[56:59], v[96:99], v[112:115], v[56:59]
    ds_read_b64_tr_b16 v[94:95], v13 offset:25600
    ds_read_b128 v[124:127], v5 offset:18432
    v_mfma_f32_16x16x32_bf16 v[60:63], v[96:99], v[116:119], v[60:63]
    ds_read_b64_tr_b16 v[96:97], v10 offset:24576
    v_mfma_f32_16x16x32_bf16 v[68:71], v[100:103], v[116:119], v[68:71]
    ds_read_b64_tr_b16 v[98:99], v14 offset:25600
    v_mfma_f32_16x16x32_bf16 v[64:67], v[100:103], v[112:115], v[64:67]
    ds_read_b64_tr_b16 v[100:101], v11 offset:24576
    s_waitcnt lgkmcnt(9)
    v_mfma_f32_16x16x32_bf16 v[72:75], v[104:107], v[112:115], v[72:75]
    ds_read_b64_tr_b16 v[102:103], v15 offset:25600
    v_mfma_f32_16x16x32_bf16 v[76:79], v[104:107], v[116:119], v[76:79]
    ds_read_b64_tr_b16 v[104:105], v12 offset:24576
    v_mfma_f32_16x16x32_bf16 v[84:87], v[108:111], v[116:119], v[84:87]
    ds_read_b64_tr_b16 v[106:107], v8 offset:25600
    v_mfma_f32_16x16x32_bf16 v[80:83], v[108:111], v[112:115], v[80:83]
    ds_read_b64_tr_b16 v[108:109], v13 offset:24576
    s_waitcnt lgkmcnt(8)
    v_mfma_f32_16x16x32_bf16 v[24:27], v[88:91], v[120:123], v[24:27]
    ds_read_b64_tr_b16 v[110:111], v9 offset:25600
    s_waitcnt lgkmcnt(8)
    v_mfma_f32_16x16x32_bf16 v[28:31], v[88:91], v[124:127], v[28:31]
    ds_read_b64_tr_b16 v[88:89], v14 offset:24576
    v_mfma_f32_16x16x32_bf16 v[36:39], v[92:95], v[124:127], v[36:39]
    ds_read_b64_tr_b16 v[90:91], v10 offset:25600
    v_mfma_f32_16x16x32_bf16 v[32:35], v[92:95], v[120:123], v[32:35]
    ds_read_b64_tr_b16 v[92:93], v15 offset:24576
    s_barrier
    s_waitcnt lgkmcnt(7)
    v_mfma_f32_16x16x32_bf16 v[40:43], v[96:99], v[120:123], v[40:43]
    ds_read_b64_tr_b16 v[94:95], v11 offset:25600
    ds_read_b128 v[112:115], v4 offset:32768
    v_mfma_f32_16x16x32_bf16 v[44:47], v[96:99], v[124:127], v[44:47]
    ds_read_b64_tr_b16 v[96:97], v8 offset:32768
    v_mfma_f32_16x16x32_bf16 v[52:55], v[100:103], v[124:127], v[52:55]
    ds_read_b64_tr_b16 v[98:99], v12 offset:33792
    v_mfma_f32_16x16x32_bf16 v[48:51], v[100:103], v[120:123], v[48:51]
    ds_read_b64_tr_b16 v[100:101], v9 offset:32768
    s_waitcnt lgkmcnt(8)
    v_mfma_f32_16x16x32_bf16 v[56:59], v[104:107], v[120:123], v[56:59]
    ds_read_b64_tr_b16 v[102:103], v13 offset:33792
    ds_read_b128 v[116:119], v4 offset:34816
    v_mfma_f32_16x16x32_bf16 v[60:63], v[104:107], v[124:127], v[60:63]
    ds_read_b64_tr_b16 v[104:105], v10 offset:32768
    v_mfma_f32_16x16x32_bf16 v[68:71], v[108:111], v[124:127], v[68:71]
    ds_read_b64_tr_b16 v[106:107], v14 offset:33792
    v_mfma_f32_16x16x32_bf16 v[64:67], v[108:111], v[120:123], v[64:67]
    ds_read_b64_tr_b16 v[108:109], v11 offset:32768
    s_waitcnt lgkmcnt(9)
    v_mfma_f32_16x16x32_bf16 v[72:75], v[88:91], v[120:123], v[72:75]
    ds_read_b64_tr_b16 v[110:111], v15 offset:33792
    v_mfma_f32_16x16x32_bf16 v[76:79], v[88:91], v[124:127], v[76:79]
    ds_read_b64_tr_b16 v[88:89], v12 offset:32768
    v_mfma_f32_16x16x32_bf16 v[84:87], v[92:95], v[124:127], v[84:87]
    ds_read_b64_tr_b16 v[90:91], v8 offset:33792
    v_mfma_f32_16x16x32_bf16 v[80:83], v[92:95], v[120:123], v[80:83]
    ds_read_b64_tr_b16 v[92:93], v13 offset:32768
    s_waitcnt lgkmcnt(8)
    v_mfma_f32_16x16x32_bf16 v[24:27], v[96:99], v[112:115], v[24:27]
    ds_read_b64_tr_b16 v[94:95], v9 offset:33792
    s_waitcnt lgkmcnt(8)
    v_mfma_f32_16x16x32_bf16 v[28:31], v[96:99], v[116:119], v[28:31]
    ds_read_b64_tr_b16 v[96:97], v14 offset:32768
    v_mfma_f32_16x16x32_bf16 v[36:39], v[100:103], v[116:119], v[36:39]
    ds_read_b64_tr_b16 v[98:99], v10 offset:33792
    v_mfma_f32_16x16x32_bf16 v[32:35], v[100:103], v[112:115], v[32:35]
    ds_read_b64_tr_b16 v[100:101], v15 offset:32768
    s_waitcnt lgkmcnt(7)
    v_mfma_f32_16x16x32_bf16 v[40:43], v[104:107], v[112:115], v[40:43]
    ds_read_b64_tr_b16 v[102:103], v11 offset:33792
    ds_read_b128 v[120:123], v5 offset:32768
    v_mfma_f32_16x16x32_bf16 v[44:47], v[104:107], v[116:119], v[44:47]
    ds_read_b64_tr_b16 v[104:105], v8 offset:40960
    v_mfma_f32_16x16x32_bf16 v[52:55], v[108:111], v[116:119], v[52:55]
    ds_read_b64_tr_b16 v[106:107], v12 offset:41984
    v_mfma_f32_16x16x32_bf16 v[48:51], v[108:111], v[112:115], v[48:51]
    ds_read_b64_tr_b16 v[108:109], v9 offset:40960
    s_waitcnt lgkmcnt(8)
    v_mfma_f32_16x16x32_bf16 v[56:59], v[88:91], v[112:115], v[56:59]
    ds_read_b64_tr_b16 v[110:111], v13 offset:41984
    ds_read_b128 v[124:127], v5 offset:34816
    v_mfma_f32_16x16x32_bf16 v[60:63], v[88:91], v[116:119], v[60:63]
    ds_read_b64_tr_b16 v[88:89], v10 offset:40960
    v_mfma_f32_16x16x32_bf16 v[68:71], v[92:95], v[116:119], v[68:71]
    ds_read_b64_tr_b16 v[90:91], v14 offset:41984
    v_mfma_f32_16x16x32_bf16 v[64:67], v[92:95], v[112:115], v[64:67]
    ds_read_b64_tr_b16 v[92:93], v11 offset:40960
    s_waitcnt lgkmcnt(9)
    v_mfma_f32_16x16x32_bf16 v[72:75], v[96:99], v[112:115], v[72:75]
    ds_read_b64_tr_b16 v[94:95], v15 offset:41984
    v_mfma_f32_16x16x32_bf16 v[76:79], v[96:99], v[116:119], v[76:79]
    ds_read_b64_tr_b16 v[96:97], v12 offset:40960
    v_mfma_f32_16x16x32_bf16 v[84:87], v[100:103], v[116:119], v[84:87]
    ds_read_b64_tr_b16 v[98:99], v8 offset:41984
    v_mfma_f32_16x16x32_bf16 v[80:83], v[100:103], v[112:115], v[80:83]
    ds_read_b64_tr_b16 v[100:101], v13 offset:40960
    s_waitcnt lgkmcnt(8)
    v_mfma_f32_16x16x32_bf16 v[24:27], v[104:107], v[120:123], v[24:27]
    ds_read_b64_tr_b16 v[102:103], v9 offset:41984
    s_waitcnt lgkmcnt(8)
    v_mfma_f32_16x16x32_bf16 v[28:31], v[104:107], v[124:127], v[28:31]
    ds_read_b64_tr_b16 v[104:105], v14 offset:40960
    v_mfma_f32_16x16x32_bf16 v[36:39], v[108:111], v[124:127], v[36:39]
    ds_read_b64_tr_b16 v[106:107], v10 offset:41984
    v_mfma_f32_16x16x32_bf16 v[32:35], v[108:111], v[120:123], v[32:35]
    ds_read_b64_tr_b16 v[108:109], v15 offset:40960
    s_barrier
    s_waitcnt lgkmcnt(7)
    v_mfma_f32_16x16x32_bf16 v[40:43], v[88:91], v[120:123], v[40:43]
    ds_read_b64_tr_b16 v[110:111], v11 offset:41984
    ds_read_b128 v[112:115], v4 offset:49152
    v_mfma_f32_16x16x32_bf16 v[44:47], v[88:91], v[124:127], v[44:47]
    ds_read_b64_tr_b16 v[88:89], v8 offset:49152
    v_mfma_f32_16x16x32_bf16 v[52:55], v[92:95], v[124:127], v[52:55]
    ds_read_b64_tr_b16 v[90:91], v12 offset:50176
    v_mfma_f32_16x16x32_bf16 v[48:51], v[92:95], v[120:123], v[48:51]
    ds_read_b64_tr_b16 v[92:93], v9 offset:49152
    s_waitcnt lgkmcnt(8)
    v_mfma_f32_16x16x32_bf16 v[56:59], v[96:99], v[120:123], v[56:59]
    ds_read_b64_tr_b16 v[94:95], v13 offset:50176
    ds_read_b128 v[116:119], v4 offset:51200
    v_mfma_f32_16x16x32_bf16 v[60:63], v[96:99], v[124:127], v[60:63]
    ds_read_b64_tr_b16 v[96:97], v10 offset:49152
    v_mfma_f32_16x16x32_bf16 v[68:71], v[100:103], v[124:127], v[68:71]
    ds_read_b64_tr_b16 v[98:99], v14 offset:50176
    v_mfma_f32_16x16x32_bf16 v[64:67], v[100:103], v[120:123], v[64:67]
    ds_read_b64_tr_b16 v[100:101], v11 offset:49152
    s_waitcnt lgkmcnt(9)
    v_mfma_f32_16x16x32_bf16 v[72:75], v[104:107], v[120:123], v[72:75]
    ds_read_b64_tr_b16 v[102:103], v15 offset:50176
    v_mfma_f32_16x16x32_bf16 v[76:79], v[104:107], v[124:127], v[76:79]
    ds_read_b64_tr_b16 v[104:105], v12 offset:49152
    v_mfma_f32_16x16x32_bf16 v[84:87], v[108:111], v[124:127], v[84:87]
    ds_read_b64_tr_b16 v[106:107], v8 offset:50176
    v_mfma_f32_16x16x32_bf16 v[80:83], v[108:111], v[120:123], v[80:83]
    ds_read_b64_tr_b16 v[108:109], v13 offset:49152
    s_waitcnt lgkmcnt(8)
    v_mfma_f32_16x16x32_bf16 v[24:27], v[88:91], v[112:115], v[24:27]
    ds_read_b64_tr_b16 v[110:111], v9 offset:50176
    s_waitcnt lgkmcnt(8)
    v_mfma_f32_16x16x32_bf16 v[28:31], v[88:91], v[116:119], v[28:31]
    ds_read_b64_tr_b16 v[88:89], v14 offset:49152
    v_mfma_f32_16x16x32_bf16 v[36:39], v[92:95], v[116:119], v[36:39]
    ds_read_b64_tr_b16 v[90:91], v10 offset:50176
    v_mfma_f32_16x16x32_bf16 v[32:35], v[92:95], v[112:115], v[32:35]
    ds_read_b64_tr_b16 v[92:93], v15 offset:49152
    s_waitcnt lgkmcnt(7)
    v_mfma_f32_16x16x32_bf16 v[40:43], v[96:99], v[112:115], v[40:43]
    ds_read_b64_tr_b16 v[94:95], v11 offset:50176
    ds_read_b128 v[120:123], v5 offset:49152
    v_mfma_f32_16x16x32_bf16 v[44:47], v[96:99], v[116:119], v[44:47]
    ds_read_b64_tr_b16 v[96:97], v8 offset:57344
    v_mfma_f32_16x16x32_bf16 v[52:55], v[100:103], v[116:119], v[52:55]
    ds_read_b64_tr_b16 v[98:99], v12 offset:58368
    v_mfma_f32_16x16x32_bf16 v[48:51], v[100:103], v[112:115], v[48:51]
    ds_read_b64_tr_b16 v[100:101], v9 offset:57344
    s_waitcnt lgkmcnt(8)
    v_mfma_f32_16x16x32_bf16 v[56:59], v[104:107], v[112:115], v[56:59]
    ds_read_b64_tr_b16 v[102:103], v13 offset:58368
    ds_read_b128 v[124:127], v5 offset:51200
    v_mfma_f32_16x16x32_bf16 v[60:63], v[104:107], v[116:119], v[60:63]
    ds_read_b64_tr_b16 v[104:105], v10 offset:57344
    v_mfma_f32_16x16x32_bf16 v[68:71], v[108:111], v[116:119], v[68:71]
    ds_read_b64_tr_b16 v[106:107], v14 offset:58368
    v_mfma_f32_16x16x32_bf16 v[64:67], v[108:111], v[112:115], v[64:67]
    ds_read_b64_tr_b16 v[108:109], v11 offset:57344
    s_waitcnt lgkmcnt(9)
    v_mfma_f32_16x16x32_bf16 v[72:75], v[88:91], v[112:115], v[72:75]
    ds_read_b64_tr_b16 v[110:111], v15 offset:58368
    v_mfma_f32_16x16x32_bf16 v[76:79], v[88:91], v[116:119], v[76:79]
    ds_read_b64_tr_b16 v[88:89], v12 offset:57344
    v_mfma_f32_16x16x32_bf16 v[84:87], v[92:95], v[116:119], v[84:87]
    ds_read_b64_tr_b16 v[90:91], v8 offset:58368
    v_mfma_f32_16x16x32_bf16 v[80:83], v[92:95], v[112:115], v[80:83]
    ds_read_b64_tr_b16 v[92:93], v13 offset:57344
    s_waitcnt lgkmcnt(8)
    v_mfma_f32_16x16x32_bf16 v[24:27], v[96:99], v[120:123], v[24:27]
    ds_read_b64_tr_b16 v[94:95], v9 offset:58368
    s_waitcnt lgkmcnt(8)
    v_mfma_f32_16x16x32_bf16 v[28:31], v[96:99], v[124:127], v[28:31]
    ds_read_b64_tr_b16 v[96:97], v14 offset:57344
    v_mfma_f32_16x16x32_bf16 v[36:39], v[100:103], v[124:127], v[36:39]
    ds_read_b64_tr_b16 v[98:99], v10 offset:58368
    v_mfma_f32_16x16x32_bf16 v[32:35], v[100:103], v[120:123], v[32:35]
    ds_read_b64_tr_b16 v[100:101], v15 offset:57344
    s_barrier
    s_waitcnt lgkmcnt(7)
    v_mfma_f32_16x16x32_bf16 v[40:43], v[104:107], v[120:123], v[40:43]
    ds_read_b64_tr_b16 v[102:103], v11 offset:58368
    ds_read_b128 v[112:115], v4 offset:0
    v_mfma_f32_16x16x32_bf16 v[44:47], v[104:107], v[124:127], v[44:47]
    ds_read_b64_tr_b16 v[104:105], v8 offset:0
    v_mfma_f32_16x16x32_bf16 v[52:55], v[108:111], v[124:127], v[52:55]
    ds_read_b64_tr_b16 v[106:107], v12 offset:1024
    v_mfma_f32_16x16x32_bf16 v[48:51], v[108:111], v[120:123], v[48:51]
    ds_read_b64_tr_b16 v[108:109], v9 offset:0
    s_waitcnt lgkmcnt(8)
    v_mfma_f32_16x16x32_bf16 v[56:59], v[88:91], v[120:123], v[56:59]
    ds_read_b64_tr_b16 v[110:111], v13 offset:1024
    ds_read_b128 v[116:119], v4 offset:2048
    v_mfma_f32_16x16x32_bf16 v[60:63], v[88:91], v[124:127], v[60:63]
    ds_read_b64_tr_b16 v[88:89], v10 offset:0
    v_mfma_f32_16x16x32_bf16 v[68:71], v[92:95], v[124:127], v[68:71]
    ds_read_b64_tr_b16 v[90:91], v14 offset:1024
    v_mfma_f32_16x16x32_bf16 v[64:67], v[92:95], v[120:123], v[64:67]
    ds_read_b64_tr_b16 v[92:93], v11 offset:0
    s_waitcnt lgkmcnt(9)
    v_mfma_f32_16x16x32_bf16 v[72:75], v[96:99], v[120:123], v[72:75]
    ds_read_b64_tr_b16 v[94:95], v15 offset:1024
    v_mfma_f32_16x16x32_bf16 v[76:79], v[96:99], v[124:127], v[76:79]
    ds_read_b64_tr_b16 v[96:97], v12 offset:0
    v_mfma_f32_16x16x32_bf16 v[84:87], v[100:103], v[124:127], v[84:87]
    ds_read_b64_tr_b16 v[98:99], v8 offset:1024
    v_mfma_f32_16x16x32_bf16 v[80:83], v[100:103], v[120:123], v[80:83]
    ds_read_b64_tr_b16 v[100:101], v13 offset:0
    s_waitcnt lgkmcnt(8)
    v_mfma_f32_16x16x32_bf16 v[24:27], v[104:107], v[112:115], v[24:27]
    ds_read_b64_tr_b16 v[102:103], v9 offset:1024
    s_waitcnt lgkmcnt(8)
    v_mfma_f32_16x16x32_bf16 v[28:31], v[104:107], v[116:119], v[28:31]
    ds_read_b64_tr_b16 v[104:105], v14 offset:0
    v_mfma_f32_16x16x32_bf16 v[36:39], v[108:111], v[116:119], v[36:39]
    ds_read_b64_tr_b16 v[106:107], v10 offset:1024
    v_mfma_f32_16x16x32_bf16 v[32:35], v[108:111], v[112:115], v[32:35]
    ds_read_b64_tr_b16 v[108:109], v15 offset:0
    s_waitcnt lgkmcnt(7)
    v_mfma_f32_16x16x32_bf16 v[40:43], v[88:91], v[112:115], v[40:43]
    ds_read_b64_tr_b16 v[110:111], v11 offset:1024
    ds_read_b128 v[120:123], v5 offset:0
    v_mfma_f32_16x16x32_bf16 v[44:47], v[88:91], v[116:119], v[44:47]
    ds_read_b64_tr_b16 v[88:89], v8 offset:8192
    v_mfma_f32_16x16x32_bf16 v[52:55], v[92:95], v[116:119], v[52:55]
    ds_read_b64_tr_b16 v[90:91], v12 offset:9216
    v_mfma_f32_16x16x32_bf16 v[48:51], v[92:95], v[112:115], v[48:51]
    ds_read_b64_tr_b16 v[92:93], v9 offset:8192
    s_waitcnt lgkmcnt(8)
    v_mfma_f32_16x16x32_bf16 v[56:59], v[96:99], v[112:115], v[56:59]
    ds_read_b64_tr_b16 v[94:95], v13 offset:9216
    ds_read_b128 v[124:127], v5 offset:2048
    v_mfma_f32_16x16x32_bf16 v[60:63], v[96:99], v[116:119], v[60:63]
    ds_read_b64_tr_b16 v[96:97], v10 offset:8192
    v_mfma_f32_16x16x32_bf16 v[68:71], v[100:103], v[116:119], v[68:71]
    ds_read_b64_tr_b16 v[98:99], v14 offset:9216
    v_mfma_f32_16x16x32_bf16 v[64:67], v[100:103], v[112:115], v[64:67]
    ds_read_b64_tr_b16 v[100:101], v11 offset:8192
    s_waitcnt lgkmcnt(9)
    v_mfma_f32_16x16x32_bf16 v[72:75], v[104:107], v[112:115], v[72:75]
    ds_read_b64_tr_b16 v[102:103], v15 offset:9216
    v_mfma_f32_16x16x32_bf16 v[76:79], v[104:107], v[116:119], v[76:79]
    ds_read_b64_tr_b16 v[104:105], v12 offset:8192
    v_mfma_f32_16x16x32_bf16 v[84:87], v[108:111], v[116:119], v[84:87]
    ds_read_b64_tr_b16 v[106:107], v8 offset:9216
    v_mfma_f32_16x16x32_bf16 v[80:83], v[108:111], v[112:115], v[80:83]
    ds_read_b64_tr_b16 v[108:109], v13 offset:8192
    s_waitcnt lgkmcnt(8)
    v_mfma_f32_16x16x32_bf16 v[24:27], v[88:91], v[120:123], v[24:27]
    ds_read_b64_tr_b16 v[110:111], v9 offset:9216
    s_waitcnt lgkmcnt(8)
    v_mfma_f32_16x16x32_bf16 v[28:31], v[88:91], v[124:127], v[28:31]
    ds_read_b64_tr_b16 v[88:89], v14 offset:8192
    v_mfma_f32_16x16x32_bf16 v[36:39], v[92:95], v[124:127], v[36:39]
    ds_read_b64_tr_b16 v[90:91], v10 offset:9216
    v_mfma_f32_16x16x32_bf16 v[32:35], v[92:95], v[120:123], v[32:35]
    ds_read_b64_tr_b16 v[92:93], v15 offset:8192
    s_barrier
    s_waitcnt lgkmcnt(7)
    v_mfma_f32_16x16x32_bf16 v[40:43], v[96:99], v[120:123], v[40:43]
    ds_read_b64_tr_b16 v[94:95], v11 offset:9216
    ds_read_b128 v[112:115], v4 offset:16384
    v_mfma_f32_16x16x32_bf16 v[44:47], v[96:99], v[124:127], v[44:47]
    ds_read_b64_tr_b16 v[96:97], v8 offset:16384
    v_mfma_f32_16x16x32_bf16 v[52:55], v[100:103], v[124:127], v[52:55]
    ds_read_b64_tr_b16 v[98:99], v12 offset:17408
    v_mfma_f32_16x16x32_bf16 v[48:51], v[100:103], v[120:123], v[48:51]
    ds_read_b64_tr_b16 v[100:101], v9 offset:16384
    s_waitcnt lgkmcnt(8)
    v_mfma_f32_16x16x32_bf16 v[56:59], v[104:107], v[120:123], v[56:59]
    ds_read_b64_tr_b16 v[102:103], v13 offset:17408
    ds_read_b128 v[116:119], v4 offset:18432
    v_mfma_f32_16x16x32_bf16 v[60:63], v[104:107], v[124:127], v[60:63]
    ds_read_b64_tr_b16 v[104:105], v10 offset:16384
    v_mfma_f32_16x16x32_bf16 v[68:71], v[108:111], v[124:127], v[68:71]
    ds_read_b64_tr_b16 v[106:107], v14 offset:17408
    v_mfma_f32_16x16x32_bf16 v[64:67], v[108:111], v[120:123], v[64:67]
    ds_read_b64_tr_b16 v[108:109], v11 offset:16384
    s_waitcnt lgkmcnt(9)
    v_mfma_f32_16x16x32_bf16 v[72:75], v[88:91], v[120:123], v[72:75]
    ds_read_b64_tr_b16 v[110:111], v15 offset:17408
    v_mfma_f32_16x16x32_bf16 v[76:79], v[88:91], v[124:127], v[76:79]
    ds_read_b64_tr_b16 v[88:89], v12 offset:16384
    v_mfma_f32_16x16x32_bf16 v[84:87], v[92:95], v[124:127], v[84:87]
    ds_read_b64_tr_b16 v[90:91], v8 offset:17408
    v_mfma_f32_16x16x32_bf16 v[80:83], v[92:95], v[120:123], v[80:83]
    ds_read_b64_tr_b16 v[92:93], v13 offset:16384
    s_waitcnt lgkmcnt(8)
    v_mfma_f32_16x16x32_bf16 v[24:27], v[96:99], v[112:115], v[24:27]
    ds_read_b64_tr_b16 v[94:95], v9 offset:17408
    s_waitcnt lgkmcnt(8)
    v_mfma_f32_16x16x32_bf16 v[28:31], v[96:99], v[116:119], v[28:31]
    ds_read_b64_tr_b16 v[96:97], v14 offset:16384
    v_mfma_f32_16x16x32_bf16 v[36:39], v[100:103], v[116:119], v[36:39]
    ds_read_b64_tr_b16 v[98:99], v10 offset:17408
    v_mfma_f32_16x16x32_bf16 v[32:35], v[100:103], v[112:115], v[32:35]
    ds_read_b64_tr_b16 v[100:101], v15 offset:16384
    s_waitcnt lgkmcnt(7)
    v_mfma_f32_16x16x32_bf16 v[40:43], v[104:107], v[112:115], v[40:43]
    ds_read_b64_tr_b16 v[102:103], v11 offset:17408
    ds_read_b128 v[120:123], v5 offset:16384
    v_mfma_f32_16x16x32_bf16 v[44:47], v[104:107], v[116:119], v[44:47]
    ds_read_b64_tr_b16 v[104:105], v8 offset:24576
    v_mfma_f32_16x16x32_bf16 v[52:55], v[108:111], v[116:119], v[52:55]
    ds_read_b64_tr_b16 v[106:107], v12 offset:25600
    v_mfma_f32_16x16x32_bf16 v[48:51], v[108:111], v[112:115], v[48:51]
    ds_read_b64_tr_b16 v[108:109], v9 offset:24576
    s_waitcnt lgkmcnt(8)
    v_mfma_f32_16x16x32_bf16 v[56:59], v[88:91], v[112:115], v[56:59]
    ds_read_b64_tr_b16 v[110:111], v13 offset:25600
    ds_read_b128 v[124:127], v5 offset:18432
    v_mfma_f32_16x16x32_bf16 v[60:63], v[88:91], v[116:119], v[60:63]
    ds_read_b64_tr_b16 v[88:89], v10 offset:24576
    v_mfma_f32_16x16x32_bf16 v[68:71], v[92:95], v[116:119], v[68:71]
    ds_read_b64_tr_b16 v[90:91], v14 offset:25600
    v_mfma_f32_16x16x32_bf16 v[64:67], v[92:95], v[112:115], v[64:67]
    ds_read_b64_tr_b16 v[92:93], v11 offset:24576
    s_waitcnt lgkmcnt(9)
    v_mfma_f32_16x16x32_bf16 v[72:75], v[96:99], v[112:115], v[72:75]
    ds_read_b64_tr_b16 v[94:95], v15 offset:25600
    v_mfma_f32_16x16x32_bf16 v[76:79], v[96:99], v[116:119], v[76:79]
    ds_read_b64_tr_b16 v[96:97], v12 offset:24576
    v_mfma_f32_16x16x32_bf16 v[84:87], v[100:103], v[116:119], v[84:87]
    ds_read_b64_tr_b16 v[98:99], v8 offset:25600
    v_mfma_f32_16x16x32_bf16 v[80:83], v[100:103], v[112:115], v[80:83]
    ds_read_b64_tr_b16 v[100:101], v13 offset:24576
    s_waitcnt lgkmcnt(8)
    v_mfma_f32_16x16x32_bf16 v[24:27], v[104:107], v[120:123], v[24:27]
    ds_read_b64_tr_b16 v[102:103], v9 offset:25600
    s_waitcnt lgkmcnt(8)
    v_mfma_f32_16x16x32_bf16 v[28:31], v[104:107], v[124:127], v[28:31]
    ds_read_b64_tr_b16 v[104:105], v14 offset:24576
    v_mfma_f32_16x16x32_bf16 v[36:39], v[108:111], v[124:127], v[36:39]
    ds_read_b64_tr_b16 v[106:107], v10 offset:25600
    v_mfma_f32_16x16x32_bf16 v[32:35], v[108:111], v[120:123], v[32:35]
    ds_read_b64_tr_b16 v[108:109], v15 offset:24576
    s_barrier
    s_waitcnt lgkmcnt(7)
    v_mfma_f32_16x16x32_bf16 v[40:43], v[88:91], v[120:123], v[40:43]
    ds_read_b64_tr_b16 v[110:111], v11 offset:25600
    ds_read_b128 v[112:115], v4 offset:32768
    v_mfma_f32_16x16x32_bf16 v[44:47], v[88:91], v[124:127], v[44:47]
    ds_read_b64_tr_b16 v[88:89], v8 offset:32768
    v_mfma_f32_16x16x32_bf16 v[52:55], v[92:95], v[124:127], v[52:55]
    ds_read_b64_tr_b16 v[90:91], v12 offset:33792
    v_mfma_f32_16x16x32_bf16 v[48:51], v[92:95], v[120:123], v[48:51]
    ds_read_b64_tr_b16 v[92:93], v9 offset:32768
    s_waitcnt lgkmcnt(8)
    v_mfma_f32_16x16x32_bf16 v[56:59], v[96:99], v[120:123], v[56:59]
    ds_read_b64_tr_b16 v[94:95], v13 offset:33792
    ds_read_b128 v[116:119], v4 offset:34816
    v_mfma_f32_16x16x32_bf16 v[60:63], v[96:99], v[124:127], v[60:63]
    ds_read_b64_tr_b16 v[96:97], v10 offset:32768
    v_mfma_f32_16x16x32_bf16 v[68:71], v[100:103], v[124:127], v[68:71]
    ds_read_b64_tr_b16 v[98:99], v14 offset:33792
    v_mfma_f32_16x16x32_bf16 v[64:67], v[100:103], v[120:123], v[64:67]
    ds_read_b64_tr_b16 v[100:101], v11 offset:32768
    s_waitcnt lgkmcnt(9)
    v_mfma_f32_16x16x32_bf16 v[72:75], v[104:107], v[120:123], v[72:75]
    ds_read_b64_tr_b16 v[102:103], v15 offset:33792
    v_mfma_f32_16x16x32_bf16 v[76:79], v[104:107], v[124:127], v[76:79]
    ds_read_b64_tr_b16 v[104:105], v12 offset:32768
L_pad0:
    s_cbranch_vccnz L_pad1
    v_mfma_f32_16x16x32_bf16 v[84:87], v[108:111], v[124:127], v[84:87]
    ds_read_b64_tr_b16 v[106:107], v8 offset:33792
    v_mfma_f32_16x16x32_bf16 v[80:83], v[108:111], v[120:123], v[80:83]
    ds_read_b64_tr_b16 v[108:109], v13 offset:32768
    s_waitcnt lgkmcnt(8)
    v_mfma_f32_16x16x32_bf16 v[24:27], v[88:91], v[112:115], v[24:27]
    ds_read_b64_tr_b16 v[110:111], v9 offset:33792
    s_waitcnt lgkmcnt(8)
    v_mfma_f32_16x16x32_bf16 v[28:31], v[88:91], v[116:119], v[28:31]
    ds_read_b64_tr_b16 v[88:89], v14 offset:32768
    v_mfma_f32_16x16x32_bf16 v[36:39], v[92:95], v[116:119], v[36:39]
    ds_read_b64_tr_b16 v[90:91], v10 offset:33792
    v_mfma_f32_16x16x32_bf16 v[32:35], v[92:95], v[112:115], v[32:35]
    ds_read_b64_tr_b16 v[92:93], v15 offset:32768
    s_waitcnt lgkmcnt(7)
    v_mfma_f32_16x16x32_bf16 v[40:43], v[96:99], v[112:115], v[40:43]
    ds_read_b64_tr_b16 v[94:95], v11 offset:33792
    ds_read_b128 v[120:123], v5 offset:32768
    v_mfma_f32_16x16x32_bf16 v[44:47], v[96:99], v[116:119], v[44:47]
    ds_read_b64_tr_b16 v[96:97], v8 offset:40960
    v_mfma_f32_16x16x32_bf16 v[52:55], v[100:103], v[116:119], v[52:55]
    ds_read_b64_tr_b16 v[98:99], v12 offset:41984
    v_mfma_f32_16x16x32_bf16 v[48:51], v[100:103], v[112:115], v[48:51]
    ds_read_b64_tr_b16 v[100:101], v9 offset:40960
    s_waitcnt lgkmcnt(8)
    v_mfma_f32_16x16x32_bf16 v[56:59], v[104:107], v[112:115], v[56:59]
    ds_read_b64_tr_b16 v[102:103], v13 offset:41984
    ds_read_b128 v[124:127], v5 offset:34816
    v_mfma_f32_16x16x32_bf16 v[60:63], v[104:107], v[116:119], v[60:63]
    ds_read_b64_tr_b16 v[104:105], v10 offset:40960
    v_mfma_f32_16x16x32_bf16 v[68:71], v[108:111], v[116:119], v[68:71]
    ds_read_b64_tr_b16 v[106:107], v14 offset:41984
    v_mfma_f32_16x16x32_bf16 v[64:67], v[108:111], v[112:115], v[64:67]
    ds_read_b64_tr_b16 v[108:109], v11 offset:40960
    s_waitcnt lgkmcnt(9)
    v_mfma_f32_16x16x32_bf16 v[72:75], v[88:91], v[112:115], v[72:75]
    ds_read_b64_tr_b16 v[110:111], v15 offset:41984
    v_mfma_f32_16x16x32_bf16 v[76:79], v[88:91], v[116:119], v[76:79]
    ds_read_b64_tr_b16 v[88:89], v12 offset:40960
    v_mfma_f32_16x16x32_bf16 v[84:87], v[92:95], v[116:119], v[84:87]
    ds_read_b64_tr_b16 v[90:91], v8 offset:41984
    v_mfma_f32_16x16x32_bf16 v[80:83], v[92:95], v[112:115], v[80:83]
    ds_read_b64_tr_b16 v[92:93], v13 offset:40960
    s_waitcnt lgkmcnt(8)
    v_mfma_f32_16x16x32_bf16 v[24:27], v[96:99], v[120:123], v[24:27]
    ds_read_b64_tr_b16 v[94:95], v9 offset:41984
    s_waitcnt lgkmcnt(8)
    v_mfma_f32_16x16x32_bf16 v[28:31], v[96:99], v[124:127], v[28:31]
    ds_read_b64_tr_b16 v[96:97], v14 offset:40960
    v_mfma_f32_16x16x32_bf16 v[36:39], v[100:103], v[124:127], v[36:39]
    ds_read_b64_tr_b16 v[98:99], v10 offset:41984
    v_mfma_f32_16x16x32_bf16 v[32:35], v[100:103], v[120:123], v[32:35]
    ds_read_b64_tr_b16 v[100:101], v15 offset:40960
    s_barrier
    s_waitcnt lgkmcnt(7)
    v_mfma_f32_16x16x32_bf16 v[40:43], v[104:107], v[120:123], v[40:43]
    ds_read_b64_tr_b16 v[102:103], v11 offset:41984
    ds_read_b128 v[112:115], v4 offset:49152
    v_mfma_f32_16x16x32_bf16 v[44:47], v[104:107], v[124:127], v[44:47]
    ds_read_b64_tr_b16 v[104:105], v8 offset:49152
    v_mfma_f32_16x16x32_bf16 v[52:55], v[108:111], v[124:127], v[52:55]
    ds_read_b64_tr_b16 v[106:107], v12 offset:50176
    v_mfma_f32_16x16x32_bf16 v[48:51], v[108:111], v[120:123], v[48:51]
    ds_read_b64_tr_b16 v[108:109], v9 offset:49152
    s_waitcnt lgkmcnt(8)
    v_mfma_f32_16x16x32_bf16 v[56:59], v[88:91], v[120:123], v[56:59]
    ds_read_b64_tr_b16 v[110:111], v13 offset:50176
    ds_read_b128 v[116:119], v4 offset:51200
    v_mfma_f32_16x16x32_bf16 v[60:63], v[88:91], v[124:127], v[60:63]
    ds_read_b64_tr_b16 v[88:89], v10 offset:49152
    v_mfma_f32_16x16x32_bf16 v[68:71], v[92:95], v[124:127], v[68:71]
    ds_read_b64_tr_b16 v[90:91], v14 offset:50176
    v_mfma_f32_16x16x32_bf16 v[64:67], v[92:95], v[120:123], v[64:67]
    ds_read_b64_tr_b16 v[92:93], v11 offset:49152
    s_waitcnt lgkmcnt(9)
    v_mfma_f32_16x16x32_bf16 v[72:75], v[96:99], v[120:123], v[72:75]
    ds_read_b64_tr_b16 v[94:95], v15 offset:50176
    v_mfma_f32_16x16x32_bf16 v[76:79], v[96:99], v[124:127], v[76:79]
    ds_read_b64_tr_b16 v[96:97], v12 offset:49152
    v_mfma_f32_16x16x32_bf16 v[84:87], v[100:103], v[124:127], v[84:87]
    ds_read_b64_tr_b16 v[98:99], v8 offset:50176
    v_mfma_f32_16x16x32_bf16 v[80:83], v[100:103], v[120:123], v[80:83]
    ds_read_b64_tr_b16 v[100:101], v13 offset:49152
    s_waitcnt lgkmcnt(8)
    v_mfma_f32_16x16x32_bf16 v[24:27], v[104:107], v[112:115], v[24:27]
    ds_read_b64_tr_b16 v[102:103], v9 offset:50176
    s_waitcnt lgkmcnt(8)
    v_mfma_f32_16x16x32_bf16 v[28:31], v[104:107], v[116:119], v[28:31]
    ds_read_b64_tr_b16 v[104:105], v14 offset:49152
    v_mfma_f32_16x16x32_bf16 v[36:39], v[108:111], v[116:119], v[36:39]
    ds_read_b64_tr_b16 v[106:107], v10 offset:50176
    v_mfma_f32_16x16x32_bf16 v[32:35], v[108:111], v[112:115], v[32:35]
    ds_read_b64_tr_b16 v[108:109], v15 offset:49152
    s_waitcnt lgkmcnt(7)
    v_mfma_f32_16x16x32_bf16 v[40:43], v[88:91], v[112:115], v[40:43]
    ds_read_b64_tr_b16 v[110:111], v11 offset:50176
    ds_read_b128 v[120:123], v5 offset:49152
    v_mfma_f32_16x16x32_bf16 v[44:47], v[88:91], v[116:119], v[44:47]
    ds_read_b64_tr_b16 v[88:89], v8 offset:57344
    v_mfma_f32_16x16x32_bf16 v[52:55], v[92:95], v[116:119], v[52:55]
    ds_read_b64_tr_b16 v[90:91], v12 offset:58368
    v_mfma_f32_16x16x32_bf16 v[48:51], v[92:95], v[112:115], v[48:51]
    ds_read_b64_tr_b16 v[92:93], v9 offset:57344
    s_waitcnt lgkmcnt(8)
    v_mfma_f32_16x16x32_bf16 v[56:59], v[96:99], v[112:115], v[56:59]
    ds_read_b64_tr_b16 v[94:95], v13 offset:58368
    ds_read_b128 v[124:127], v5 offset:51200
    v_mfma_f32_16x16x32_bf16 v[60:63], v[96:99], v[116:119], v[60:63]
    ds_read_b64_tr_b16 v[96:97], v10 offset:57344
    v_mfma_f32_16x16x32_bf16 v[68:71], v[100:103], v[116:119], v[68:71]
    ds_read_b64_tr_b16 v[98:99], v14 offset:58368
    v_subrev_u32 v4, s70, v4
    v_mfma_f32_16x16x32_bf16 v[64:67], v[100:103], v[112:115], v[64:67]
    ds_read_b64_tr_b16 v[100:101], v11 offset:57344
    s_waitcnt lgkmcnt(9)
    v_mfma_f32_16x16x32_bf16 v[72:75], v[104:107], v[112:115], v[72:75]
    ds_read_b64_tr_b16 v[102:103], v15 offset:58368
    v_subrev_u32 v5, s70, v5
    v_mfma_f32_16x16x32_bf16 v[76:79], v[104:107], v[116:119], v[76:79]
    ds_read_b64_tr_b16 v[104:105], v12 offset:57344
    v_mfma_f32_16x16x32_bf16 v[84:87], v[108:111], v[116:119], v[84:87]
    ds_read_b64_tr_b16 v[106:107], v8 offset:58368
    v_mfma_f32_16x16x32_bf16 v[80:83], v[108:111], v[112:115], v[80:83]
    ds_read_b64_tr_b16 v[108:109], v13 offset:57344
    s_waitcnt lgkmcnt(8)
    v_mfma_f32_16x16x32_bf16 v[24:27], v[88:91], v[120:123], v[24:27]
    ds_read_b64_tr_b16 v[110:111], v9 offset:58368
    s_waitcnt lgkmcnt(8)
    v_mfma_f32_16x16x32_bf16 v[28:31], v[88:91], v[124:127], v[28:31]
    ds_read_b64_tr_b16 v[88:89], v14 offset:57344
    v_mfma_f32_16x16x32_bf16 v[36:39], v[92:95], v[124:127], v[36:39]
    ds_read_b64_tr_b16 v[90:91], v10 offset:58368
    v_mfma_f32_16x16x32_bf16 v[32:35], v[92:95], v[120:123], v[32:35]
    ds_read_b64_tr_b16 v[92:93], v15 offset:57344
    s_barrier
    s_waitcnt lgkmcnt(7)
    v_mfma_f32_16x16x32_bf16 v[40:43], v[96:99], v[120:123], v[40:43]
    ds_read_b64_tr_b16 v[94:95], v11 offset:58368
    v_mfma_f32_16x16x32_bf16 v[44:47], v[96:99], v[124:127], v[44:47]
    ds_read_b64 v[96:97], v160 offset:0
    v_mfma_f32_16x16x32_bf16 v[52:55], v[100:103], v[124:127], v[52:55]
    ds_read_b64 v[98:99], v161 offset:0
    v_cvt_pk_bf16_f32 v224, v24, v25
    v_mfma_f32_16x16x32_bf16 v[48:51], v[100:103], v[120:123], v[48:51]
    ds_read_b64 v[100:101], v160 offset:4096
    s_waitcnt lgkmcnt(7)
    v_mfma_f32_16x16x32_bf16 v[56:59], v[104:107], v[120:123], v[56:59]
    ds_read_b64 v[102:103], v161 offset:4096
    v_cvt_pk_bf16_f32 v225, v26, v27
    v_mfma_f32_16x16x32_bf16 v[60:63], v[104:107], v[124:127], v[60:63]
    ds_read_b64 v[104:105], v160 offset:8192
    v_cvt_pk_bf16_f32 v240, v28, v29
    v_mfma_f32_16x16x32_bf16 v[68:71], v[108:111], v[124:127], v[68:71]
    ds_read_b64 v[106:107], v161 offset:8192
    v_cvt_pk_bf16_f32 v241, v30, v31
    v_mfma_f32_16x16x32_bf16 v[64:67], v[108:111], v[120:123], v[64:67]
    ds_read_b64 v[108:109], v160 offset:12288
    v_cvt_pk_bf16_f32 v226, v32, v33
    s_waitcnt lgkmcnt(7)
    v_mfma_f32_16x16x32_bf16 v[72:75], v[88:91], v[120:123], v[72:75]
    ds_read_b64 v[110:111], v161 offset:12288
    v_cvt_pk_bf16_f32 v227, v34, v35
    v_mfma_f32_16x16x32_bf16 v[76:79], v[88:91], v[124:127], v[76:79]
    ds_read_b64 v[88:89], v162 offset:0
    v_cvt_pk_bf16_f32 v242, v36, v37
    v_mfma_f32_16x16x32_bf16 v[84:87], v[92:95], v[124:127], v[84:87]
    ds_read_b64 v[90:91], v163 offset:0
    v_cvt_pk_bf16_f32 v243, v38, v39
    v_mfma_f32_16x16x32_bf16 v[80:83], v[92:95], v[120:123], v[80:83]
    ds_read_b64 v[92:93], v162 offset:4096
    v_cvt_pk_bf16_f32 v228, v40, v41
    s_waitcnt lgkmcnt(7)
    v_mfma_f32_16x16x32_bf16 v[192:195], v[96:99], v[224:227], 0
    ds_read_b64 v[94:95], v163 offset:4096
    v_cvt_pk_bf16_f32 v229, v42, v43
    v_mfma_f32_16x16x32_bf16 v[208:211], v[96:99], v[240:243], 0
    ds_read_b64 v[96:97], v162 offset:8192
    v_cvt_pk_bf16_f32 v244, v44, v45
    v_mfma_f32_16x16x32_bf16 v[212:215], v[100:103], v[240:243], 0
    ds_read_b64 v[98:99], v163 offset:8192
    v_cvt_pk_bf16_f32 v245, v46, v47
    v_mfma_f32_16x16x32_bf16 v[196:199], v[100:103], v[224:227], 0
    ds_read_b64 v[100:101], v162 offset:12288
    v_cvt_pk_bf16_f32 v230, v48, v49
    s_waitcnt lgkmcnt(7)
    v_mfma_f32_16x16x32_bf16 v[200:203], v[104:107], v[224:227], 0
    ds_read_b64 v[102:103], v163 offset:12288
    v_cvt_pk_bf16_f32 v231, v50, v51
    v_mfma_f32_16x16x32_bf16 v[216:219], v[104:107], v[240:243], 0
    ds_read_b64 v[104:105], v164 offset:0
    v_cvt_pk_bf16_f32 v246, v52, v53
    v_mfma_f32_16x16x32_bf16 v[220:223], v[108:111], v[240:243], 0
    ds_read_b64 v[106:107], v165 offset:0
    v_cvt_pk_bf16_f32 v247, v54, v55
    v_mfma_f32_16x16x32_bf16 v[204:207], v[108:111], v[224:227], 0
    ds_read_b64 v[108:109], v164 offset:4096
    v_cvt_pk_bf16_f32 v232, v56, v57
    s_waitcnt lgkmcnt(7)
    v_mfma_f32_16x16x32_bf16 v[192:195], v[88:91], v[228:231], v[192:195]
    ds_read_b64 v[110:111], v165 offset:4096
    v_xor_b32 v8, s71, v8
    v_cvt_pk_bf16_f32 v233, v58, v59
    v_mfma_f32_16x16x32_bf16 v[208:211], v[88:91], v[244:247], v[208:211]
    ds_read_b64 v[88:89], v164 offset:8192
    v_cvt_pk_bf16_f32 v248, v60, v61
    v_mfma_f32_16x16x32_bf16 v[212:215], v[92:95], v[244:247], v[212:215]
    ds_read_b64 v[90:91], v165 offset:8192
    v_xor_b32 v9, s71, v9
    v_cvt_pk_bf16_f32 v249, v62, v63
    v_mfma_f32_16x16x32_bf16 v[196:199], v[92:95], v[228:231], v[196:199]
    ds_read_b64 v[92:93], v164 offset:12288
    v_cvt_pk_bf16_f32 v234, v64, v65
    s_waitcnt lgkmcnt(7)
    v_mfma_f32_16x16x32_bf16 v[200:203], v[96:99], v[228:231], v[200:203]
    ds_read_b64 v[94:95], v165 offset:12288
    v_xor_b32 v12, s71, v12
    v_cvt_pk_bf16_f32 v235, v66, v67
    v_mfma_f32_16x16x32_bf16 v[216:219], v[96:99], v[244:247], v[216:219]
    ds_read_b64 v[96:97], v166 offset:0
    v_cvt_pk_bf16_f32 v250, v68, v69
    v_mfma_f32_16x16x32_bf16 v[220:223], v[100:103], v[244:247], v[220:223]
    ds_read_b64 v[98:99], v167 offset:0
    v_xor_b32 v13, s71, v13
    v_cvt_pk_bf16_f32 v251, v70, v71
    v_mfma_f32_16x16x32_bf16 v[204:207], v[100:103], v[228:231], v[204:207]
    ds_read_b64 v[100:101], v166 offset:4096
    s_waitcnt lgkmcnt(7)
    v_mfma_f32_16x16x32_bf16 v[192:195], v[104:107], v[232:235], v[192:195]
    ds_read_b64 v[102:103], v167 offset:4096
    v_cvt_pk_bf16_f32 v236, v72, v73
    v_mfma_f32_16x16x32_bf16 v[208:211], v[104:107], v[248:251], v[208:211]
    ds_read_b64 v[104:105], v166 offset:8192
    v_cvt_pk_bf16_f32 v237, v74, v75
    v_mfma_f32_16x16x32_bf16 v[212:215], v[108:111], v[248:251], v[212:215]
    ds_read_b64 v[106:107], v167 offset:8192
    v_cvt_pk_bf16_f32 v252, v76, v77
    v_mfma_f32_16x16x32_bf16 v[196:199], v[108:111], v[232:235], v[196:199]
    ds_read_b64 v[108:109], v166 offset:12288
    s_waitcnt lgkmcnt(7)
    v_mfma_f32_16x16x32_bf16 v[200:203], v[88:91], v[232:235], v[200:203]
    ds_read_b64 v[110:111], v167 offset:12288
    v_cvt_pk_bf16_f32 v253, v78, v79
    v_mfma_f32_16x16x32_bf16 v[216:219], v[88:91], v[248:251], v[216:219]
    v_cvt_pk_bf16_f32 v238, v80, v81
    v_cvt_pk_bf16_f32 v239, v82, v83
    v_mfma_f32_16x16x32_bf16 v[220:223], v[92:95], v[248:251], v[220:223]
    v_cvt_pk_bf16_f32 v254, v84, v85
    v_cvt_pk_bf16_f32 v255, v86, v87
    v_mfma_f32_16x16x32_bf16 v[204:207], v[92:95], v[232:235], v[204:207]
    s_waitcnt lgkmcnt(4)
    v_mfma_f32_16x16x32_bf16 v[192:195], v[96:99], v[236:239], v[192:195]
    v_mfma_f32_16x16x32_bf16 v[208:211], v[96:99], v[252:255], v[208:211]
    v_mfma_f32_16x16x32_bf16 v[212:215], v[100:103], v[252:255], v[212:215]
    v_mfma_f32_16x16x32_bf16 v[196:199], v[100:103], v[236:239], v[196:199]
    s_waitcnt lgkmcnt(0)
    v_mfma_f32_16x16x32_bf16 v[200:203], v[104:107], v[236:239], v[200:203]
    v_mfma_f32_16x16x32_bf16 v[216:219], v[104:107], v[252:255], v[216:219]
    v_mfma_f32_16x16x32_bf16 v[220:223], v[108:111], v[252:255], v[220:223]
    v_mfma_f32_16x16x32_bf16 v[204:207], v[108:111], v[236:239], v[204:207]
    s_nop 2
    v_max3_f32 v18, v192, v193, v194
    v_max3_f32 v20, v208, v209, v210
    v_max3_f32 v18, v18, v195, v196
    v_max3_f32 v20, v20, v211, v212
    v_max3_f32 v18, v18, v197, v198
    v_max3_f32 v20, v20, v213, v214
    v_max3_f32 v18, v18, v199, v200
    v_max3_f32 v20, v20, v215, v216
    v_max3_f32 v18, v18, v201, v202
    v_max3_f32 v20, v20, v217, v218
    v_max3_f32 v18, v18, v203, v204
    v_max3_f32 v20, v20, v219, v220
    v_max3_f32 v18, v18, v205, v206
    v_max3_f32 v20, v20, v221, v222
    v_max_f32 v18, v18, v207
    v_max_f32 v20, v20, v223
    s_nop 0
    s_nop 0
    v_permlane32_swap_b32 v18, v20
    v_max_f32 v18, v18, v20
    v_mov_b32 v20, v18
    s_nop 0
    s_nop 0
    v_permlane16_swap_b32 v18, v20
    v_max_f32 v18, v18, v20
    v_mul_f32 v20, s68, v18
    v_mul_f32 v18, s68, v18
    s_nop 0
    s_nop 0
    v_permlane32_swap_b32 v18, v20
    v_pk_fma_f32 v[192:193], v[192:193], s[68:69], v[18:19] op_sel_hi:[1,1,0] neg_lo:[0,0,1] neg_hi:[0,0,1]
    v_exp_f32 v192, v192
    v_pk_fma_f32 v[194:195], v[194:195], s[68:69], v[18:19] op_sel_hi:[1,1,0] neg_lo:[0,0,1] neg_hi:[0,0,1]
    v_exp_f32 v193, v193
    v_exp_f32 v194, v194
    v_pk_fma_f32 v[196:197], v[196:197], s[68:69], v[18:19] op_sel_hi:[1,1,0] neg_lo:[0,0,1] neg_hi:[0,0,1]
    v_exp_f32 v195, v195
    v_exp_f32 v196, v196
    v_pk_fma_f32 v[198:199], v[198:199], s[68:69], v[18:19] op_sel_hi:[1,1,0] neg_lo:[0,0,1] neg_hi:[0,0,1]
    v_exp_f32 v197, v197
    v_pk_add_f32 v[22:23], v[192:193], v[194:195]
    v_exp_f32 v198, v198
    v_pk_fma_f32 v[200:201], v[200:201], s[68:69], v[18:19] op_sel_hi:[1,1,0] neg_lo:[0,0,1] neg_hi:[0,0,1]
    v_exp_f32 v199, v199
    v_pk_add_f32 v[22:23], v[22:23], v[196:197]
    v_exp_f32 v200, v200
    v_pk_fma_f32 v[202:203], v[202:203], s[68:69], v[18:19] op_sel_hi:[1,1,0] neg_lo:[0,0,1] neg_hi:[0,0,1]
    v_exp_f32 v201, v201
    v_pk_add_f32 v[22:23], v[22:23], v[198:199]
    v_exp_f32 v202, v202
    v_pk_fma_f32 v[204:205], v[204:205], s[68:69], v[18:19] op_sel_hi:[1,1,0] neg_lo:[0,0,1] neg_hi:[0,0,1]
    v_exp_f32 v203, v203
    v_pk_add_f32 v[22:23], v[22:23], v[200:201]
    v_exp_f32 v204, v204
    v_pk_fma_f32 v[206:207], v[206:207], s[68:69], v[18:19] op_sel_hi:[1,1,0] neg_lo:[0,0,1] neg_hi:[0,0,1]
    v_exp_f32 v205, v205
    v_pk_add_f32 v[22:23], v[22:23], v[202:203]
    v_exp_f32 v206, v206
    v_pk_fma_f32 v[208:209], v[208:209], s[68:69], v[20:21] op_sel_hi:[1,1,0] neg_lo:[0,0,1] neg_hi:[0,0,1]
    v_exp_f32 v207, v207
    v_pk_add_f32 v[22:23], v[22:23], v[204:205]
    v_exp_f32 v208, v208
    v_pk_fma_f32 v[210:211], v[210:211], s[68:69], v[20:21] op_sel_hi:[1,1,0] neg_lo:[0,0,1] neg_hi:[0,0,1]
    v_exp_f32 v209, v209
    v_pk_add_f32 v[22:23], v[22:23], v[206:207]
    v_exp_f32 v210, v210
    v_pk_fma_f32 v[212:213], v[212:213], s[68:69], v[20:21] op_sel_hi:[1,1,0] neg_lo:[0,0,1] neg_hi:[0,0,1]
    v_exp_f32 v211, v211
    v_exp_f32 v212, v212
    v_pk_fma_f32 v[214:215], v[214:215], s[68:69], v[20:21] op_sel_hi:[1,1,0] neg_lo:[0,0,1] neg_hi:[0,0,1]
    v_exp_f32 v213, v213
    v_pk_add_f32 v[2:3], v[208:209], v[210:211]
    v_exp_f32 v214, v214
    v_pk_fma_f32 v[216:217], v[216:217], s[68:69], v[20:21] op_sel_hi:[1,1,0] neg_lo:[0,0,1] neg_hi:[0,0,1]
    v_exp_f32 v215, v215
    v_pk_add_f32 v[2:3], v[2:3], v[212:213]
    v_exp_f32 v216, v216
    v_pk_fma_f32 v[218:219], v[218:219], s[68:69], v[20:21] op_sel_hi:[1,1,0] neg_lo:[0,0,1] neg_hi:[0,0,1]
    v_exp_f32 v217, v217
    v_pk_add_f32 v[2:3], v[2:3], v[214:215]
    v_exp_f32 v218, v218
    v_pk_fma_f32 v[220:221], v[220:221], s[68:69], v[20:21] op_sel_hi:[1,1,0] neg_lo:[0,0,1] neg_hi:[0,0,1]
    v_exp_f32 v219, v219
    v_pk_add_f32 v[2:3], v[2:3], v[216:217]
    v_exp_f32 v220, v220
    v_pk_fma_f32 v[222:223], v[222:223], s[68:69], v[20:21] op_sel_hi:[1,1,0] neg_lo:[0,0,1] neg_hi:[0,0,1]
    v_exp_f32 v221, v221
    v_pk_add_f32 v[2:3], v[2:3], v[218:219]
    v_exp_f32 v222, v222
    v_exp_f32 v223, v223
    v_pk_add_f32 v[2:3], v[2:3], v[220:221]
    v_add_f32 v18, v22, v23
    v_pk_add_f32 v[2:3], v[2:3], v[222:223]
    v_add_f32 v20, v2, v3
    s_nop 0
    s_nop 0
    v_permlane32_swap_b32 v18, v20
    v_add_f32 v18, v18, v20
    v_mov_b32 v20, v18
    s_nop 0
    s_nop 0
    v_permlane16_swap_b32 v18, v20
    v_add_f32 v18, v18, v20
    v_rcp_f32 v20, v18
    v_rcp_f32 v18, v18
    s_nop 0
    s_nop 0
    v_permlane32_swap_b32 v18, v20
    v_pk_mul_f32 v[192:193], v[192:193], v[18:19] op_sel_hi:[1,0]
    v_pk_mul_f32 v[194:195], v[194:195], v[18:19] op_sel_hi:[1,0]
    v_pk_mul_f32 v[196:197], v[196:197], v[18:19] op_sel_hi:[1,0]
    v_pk_mul_f32 v[198:199], v[198:199], v[18:19] op_sel_hi:[1,0]
    v_cvt_pk_bf16_f32 v176, v192, v193
    v_cvt_pk_bf16_f32 v177, v194, v195
    v_cvt_pk_bf16_f32 v178, v196, v197
    v_cvt_pk_bf16_f32 v179, v198, v199
    ds_write_b128 v17, v[176:179] offset:49152
    buffer_store_dwordx4 v[176:179], v17, s[56:59], s64 offen offset:0 sc1
    v_pk_mul_f32 v[200:201], v[200:201], v[18:19] op_sel_hi:[1,0]
    v_pk_mul_f32 v[202:203], v[202:203], v[18:19] op_sel_hi:[1,0]
    v_pk_mul_f32 v[204:205], v[204:205], v[18:19] op_sel_hi:[1,0]
    v_pk_mul_f32 v[206:207], v[206:207], v[18:19] op_sel_hi:[1,0]
    v_cvt_pk_bf16_f32 v180, v200, v201
    v_cvt_pk_bf16_f32 v181, v202, v203
    v_cvt_pk_bf16_f32 v182, v204, v205
    v_cvt_pk_bf16_f32 v183, v206, v207
    ds_write_b128 v17, v[180:183] offset:50176
    buffer_store_dwordx4 v[180:183], v17, s[56:59], s64 offen offset:1024 sc1
    v_pk_mul_f32 v[208:209], v[208:209], v[20:21] op_sel_hi:[1,0]
    v_pk_mul_f32 v[210:211], v[210:211], v[20:21] op_sel_hi:[1,0]
    v_pk_mul_f32 v[212:213], v[212:213], v[20:21] op_sel_hi:[1,0]
    v_pk_mul_f32 v[214:215], v[214:215], v[20:21] op_sel_hi:[1,0]
    v_cvt_pk_bf16_f32 v184, v208, v209
    v_cvt_pk_bf16_f32 v185, v210, v211
    v_cvt_pk_bf16_f32 v186, v212, v213
    v_cvt_pk_bf16_f32 v187, v214, v215
    ds_write_b128 v17, v[184:187] offset:51200
    buffer_store_dwordx4 v[184:187], v17, s[56:59], s64 offen offset:2048 sc1
    v_pk_mul_f32 v[216:217], v[216:217], v[20:21] op_sel_hi:[1,0]
    v_pk_mul_f32 v[218:219], v[218:219], v[20:21] op_sel_hi:[1,0]
    v_pk_mul_f32 v[220:221], v[220:221], v[20:21] op_sel_hi:[1,0]
    v_pk_mul_f32 v[222:223], v[222:223], v[20:21] op_sel_hi:[1,0]
    v_cvt_pk_bf16_f32 v188, v216, v217
    v_cvt_pk_bf16_f32 v189, v218, v219
    v_cvt_pk_bf16_f32 v190, v220, v221
    v_cvt_pk_bf16_f32 v191, v222, v223
    ds_write_b128 v17, v[188:191] offset:52224
    buffer_store_dwordx4 v[188:191], v17, s[56:59], s64 offen offset:3072 sc1
    s_barrier
    ds_read_b64_tr_b16 v[112:113], v8 offset:0
    ds_read_b64_tr_b16 v[114:115], v12 offset:1024
    ds_read_b64_tr_b16 v[116:117], v9 offset:0
    ds_read_b64_tr_b16 v[118:119], v13 offset:1024
    ds_read_b128 v[88:91], v4 offset:0
    ds_read_b128 v[92:95], v4 offset:2048
    ds_read_b128 v[96:99], v4 offset:4096
    ds_read_b128 v[100:103], v4 offset:6144
    ds_read_b128 v[104:107], v4 offset:8192
    ds_read_b128 v[108:111], v4 offset:10240
    s_waitcnt lgkmcnt(5)
    v_mfma_f32_16x16x32_bf16 v[24:27], v[88:91], v[112:115], 0
    v_mfma_f32_16x16x32_bf16 v[28:31], v[88:91], v[116:119], 0
    ds_read_b128 v[88:91], v4 offset:12288
    s_waitcnt lgkmcnt(5)
    v_mfma_f32_16x16x32_bf16 v[36:39], v[92:95], v[116:119], 0
    v_mfma_f32_16x16x32_bf16 v[32:35], v[92:95], v[112:115], 0
    ds_read_b128 v[92:95], v4 offset:14336
    s_waitcnt lgkmcnt(4)
    v_mfma_f32_16x16x32_bf16 v[40:43], v[96:99], v[112:115], 0
    ds_read_b64_tr_b16 v[120:121], v8 offset:8192
    v_mfma_f32_16x16x32_bf16 v[44:47], v[96:99], v[116:119], 0
    ds_read_b128 v[96:99], v5 offset:0
    v_mfma_f32_16x16x32_bf16 v[52:55], v[100:103], v[116:119], 0
    ds_read_b64_tr_b16 v[122:123], v12 offset:9216
    v_mfma_f32_16x16x32_bf16 v[48:51], v[100:103], v[112:115], 0
    ds_read_b128 v[100:103], v5 offset:2048
    s_waitcnt lgkmcnt(6)
    v_mfma_f32_16x16x32_bf16 v[56:59], v[104:107], v[112:115], 0
    ds_read_b64_tr_b16 v[124:125], v9 offset:8192
    v_mfma_f32_16x16x32_bf16 v[60:63], v[104:107], v[116:119], 0
    ds_read_b128 v[104:107], v5 offset:4096
    v_mfma_f32_16x16x32_bf16 v[68:71], v[108:111], v[116:119], 0
    ds_read_b64_tr_b16 v[126:127], v13 offset:9216
    v_mfma_f32_16x16x32_bf16 v[64:67], v[108:111], v[112:115], 0
    ds_read_b128 v[108:111], v5 offset:6144
    s_waitcnt lgkmcnt(8)
    v_mfma_f32_16x16x32_bf16 v[72:75], v[88:91], v[112:115], 0
    v_mfma_f32_16x16x32_bf16 v[76:79], v[88:91], v[116:119], 0
    ds_read_b128 v[88:91], v5 offset:8192
    v_add_u32 v10, 0x10000, v16
    v_mfma_f32_16x16x32_bf16 v[84:87], v[92:95], v[116:119], 0
    v_mfma_f32_16x16x32_bf16 v[80:83], v[92:95], v[112:115], 0
    ds_read_b128 v[92:95], v5 offset:10240
    v_add_u32 v11, 0x20000, v16
    s_waitcnt lgkmcnt(6)
    v_mfma_f32_16x16x32_bf16 v[24:27], v[96:99], v[120:123], v[24:27]
    s_waitcnt lgkmcnt(3)
    v_mfma_f32_16x16x32_bf16 v[28:31], v[96:99], v[124:127], v[28:31]
    ds_read_b128 v[96:99], v5 offset:12288
    v_mfma_f32_16x16x32_bf16 v[36:39], v[100:103], v[124:127], v[36:39]
    v_mfma_f32_16x16x32_bf16 v[32:35], v[100:103], v[120:123], v[32:35]
    ds_read_b128 v[100:103], v5 offset:14336
    s_barrier
    s_waitcnt lgkmcnt(4)
    v_mfma_f32_16x16x32_bf16 v[40:43], v[104:107], v[120:123], v[40:43]
    ds_read_b64_tr_b16 v[112:113], v8 offset:16384
    v_mfma_f32_16x16x32_bf16 v[44:47], v[104:107], v[124:127], v[44:47]
    ds_read_b128 v[104:107], v4 offset:16384
    v_mfma_f32_16x16x32_bf16 v[52:55], v[108:111], v[124:127], v[52:55]
    ds_read_b64_tr_b16 v[114:115], v12 offset:17408
    v_mfma_f32_16x16x32_bf16 v[48:51], v[108:111], v[120:123], v[48:51]
    ds_read_b128 v[108:111], v4 offset:18432
    s_waitcnt lgkmcnt(6)
    v_mfma_f32_16x16x32_bf16 v[56:59], v[88:91], v[120:123], v[56:59]
    ds_read_b64_tr_b16 v[116:117], v9 offset:16384
    v_mfma_f32_16x16x32_bf16 v[60:63], v[88:91], v[124:127], v[60:63]
    ds_read_b128 v[88:91], v4 offset:20480
    v_mfma_f32_16x16x32_bf16 v[68:71], v[92:95], v[124:127], v[68:71]
    ds_read_b64_tr_b16 v[118:119], v13 offset:17408
    v_mfma_f32_16x16x32_bf16 v[64:67], v[92:95], v[120:123], v[64:67]
    ds_read_b128 v[92:95], v4 offset:22528
    s_waitcnt lgkmcnt(8)
    v_mfma_f32_16x16x32_bf16 v[72:75], v[96:99], v[120:123], v[72:75]
    v_mfma_f32_16x16x32_bf16 v[76:79], v[96:99], v[124:127], v[76:79]
    ds_read_b128 v[96:99], v4 offset:24576
    v_mfma_f32_16x16x32_bf16 v[84:87], v[100:103], v[124:127], v[84:87]
    v_mfma_f32_16x16x32_bf16 v[80:83], v[100:103], v[120:123], v[80:83]
    ds_read_b128 v[100:103], v4 offset:26624
    s_waitcnt lgkmcnt(6)
    v_mfma_f32_16x16x32_bf16 v[24:27], v[104:107], v[112:115], v[24:27]
    s_waitcnt lgkmcnt(3)
    v_mfma_f32_16x16x32_bf16 v[28:31], v[104:107], v[116:119], v[28:31]
    ds_read_b128 v[104:107], v4 offset:28672
    v_mfma_f32_16x16x32_bf16 v[36:39], v[108:111], v[116:119], v[36:39]
    v_mfma_f32_16x16x32_bf16 v[32:35], v[108:111], v[112:115], v[32:35]
    ds_read_b128 v[108:111], v4 offset:30720
    s_waitcnt lgkmcnt(4)
    v_mfma_f32_16x16x32_bf16 v[40:43], v[88:91], v[112:115], v[40:43]
    ds_read_b64_tr_b16 v[120:121], v8 offset:24576
    v_mfma_f32_16x16x32_bf16 v[44:47], v[88:91], v[116:119], v[44:47]
    ds_read_b128 v[88:91], v5 offset:16384
    v_mfma_f32_16x16x32_bf16 v[52:55], v[92:95], v[116:119], v[52:55]
    ds_read_b64_tr_b16 v[122:123], v12 offset:25600
    v_mfma_f32_16x16x32_bf16 v[48:51], v[92:95], v[112:115], v[48:51]
    ds_read_b128 v[92:95], v5 offset:18432
    s_waitcnt lgkmcnt(6)
    v_mfma_f32_16x16x32_bf16 v[56:59], v[96:99], v[112:115], v[56:59]
    ds_read_b64_tr_b16 v[124:125], v9 offset:24576
    v_mfma_f32_16x16x32_bf16 v[60:63], v[96:99], v[116:119], v[60:63]
    ds_read_b128 v[96:99], v5 offset:20480
    v_mfma_f32_16x16x32_bf16 v[68:71], v[100:103], v[116:119], v[68:71]
    ds_read_b64_tr_b16 v[126:127], v13 offset:25600
    v_mfma_f32_16x16x32_bf16 v[64:67], v[100:103], v[112:115], v[64:67]
    ds_read_b128 v[100:103], v5 offset:22528
    s_waitcnt lgkmcnt(8)
    v_mfma_f32_16x16x32_bf16 v[72:75], v[104:107], v[112:115], v[72:75]
    v_mfma_f32_16x16x32_bf16 v[76:79], v[104:107], v[116:119], v[76:79]
    ds_read_b128 v[104:107], v5 offset:24576
    v_mfma_f32_16x16x32_bf16 v[84:87], v[108:111], v[116:119], v[84:87]
    v_mfma_f32_16x16x32_bf16 v[80:83], v[108:111], v[112:115], v[80:83]
    ds_read_b128 v[108:111], v5 offset:26624
    s_waitcnt lgkmcnt(6)
    v_mfma_f32_16x16x32_bf16 v[24:27], v[88:91], v[120:123], v[24:27]
    s_waitcnt lgkmcnt(3)
    v_mfma_f32_16x16x32_bf16 v[28:31], v[88:91], v[124:127], v[28:31]
    ds_read_b128 v[88:91], v5 offset:28672
    v_mfma_f32_16x16x32_bf16 v[36:39], v[92:95], v[124:127], v[36:39]
    v_mfma_f32_16x16x32_bf16 v[32:35], v[92:95], v[120:123], v[32:35]
    ds_read_b128 v[92:95], v5 offset:30720
    s_waitcnt lgkmcnt(4)
    v_mfma_f32_16x16x32_bf16 v[40:43], v[96:99], v[120:123], v[40:43]
    v_mfma_f32_16x16x32_bf16 v[44:47], v[96:99], v[124:127], v[44:47]
    ds_read_b128 v[96:99], v16 offset:49152
    v_mfma_f32_16x16x32_bf16 v[52:55], v[100:103], v[124:127], v[52:55]
    v_cvt_pk_bf16_f32 v24, v24, v25
    v_cvt_pk_bf16_f32 v25, v26, v27
    v_mfma_f32_16x16x32_bf16 v[48:51], v[100:103], v[120:123], v[48:51]
    ds_read_b128 v[100:103], v16 offset:51200
    s_waitcnt lgkmcnt(4)
    v_mfma_f32_16x16x32_bf16 v[56:59], v[104:107], v[120:123], v[56:59]
    v_cvt_pk_bf16_f32 v28, v28, v29
    v_cvt_pk_bf16_f32 v29, v30, v31
    v_mfma_f32_16x16x32_bf16 v[60:63], v[104:107], v[124:127], v[60:63]
    ds_read_b128 v[104:107], v16 offset:53248
    v_cvt_pk_bf16_f32 v26, v32, v33
    v_mfma_f32_16x16x32_bf16 v[68:71], v[108:111], v[124:127], v[68:71]
    v_cvt_pk_bf16_f32 v27, v34, v35
    v_cvt_pk_bf16_f32 v30, v36, v37
    v_mfma_f32_16x16x32_bf16 v[64:67], v[108:111], v[120:123], v[64:67]
    ds_read_b128 v[108:111], v16 offset:55296
    s_waitcnt lgkmcnt(4)
    v_mfma_f32_16x16x32_bf16 v[72:75], v[88:91], v[120:123], v[72:75]
    v_cvt_pk_bf16_f32 v31, v38, v39
    v_cvt_pk_bf16_f32 v40, v40, v41
    v_mfma_f32_16x16x32_bf16 v[76:79], v[88:91], v[124:127], v[76:79]
    ds_read_b128 v[88:91], v16 offset:50176
    v_cvt_pk_bf16_f32 v41, v42, v43
    v_mfma_f32_16x16x32_bf16 v[84:87], v[92:95], v[124:127], v[84:87]
    v_cvt_pk_bf16_f32 v44, v44, v45
    v_cvt_pk_bf16_f32 v45, v46, v47
    v_mfma_f32_16x16x32_bf16 v[80:83], v[92:95], v[120:123], v[80:83]
    ds_read_b128 v[92:95], v16 offset:52224
    s_waitcnt lgkmcnt(4)
    v_mfma_f32_16x16x32_bf16 v[192:195], v[24:27], v[96:99], 0
    v_cvt_pk_bf16_f32 v42, v48, v49
    v_cvt_pk_bf16_f32 v43, v50, v51
    v_mfma_f32_16x16x32_bf16 v[196:199], v[28:31], v[96:99], 0
    ds_read_b128 v[96:99], v16 offset:54272
    v_cvt_pk_bf16_f32 v46, v52, v53
    v_mfma_f32_16x16x32_bf16 v[204:207], v[28:31], v[100:103], 0
    v_cvt_pk_bf16_f32 v47, v54, v55
    v_cvt_pk_bf16_f32 v56, v56, v57
    v_mfma_f32_16x16x32_bf16 v[200:203], v[24:27], v[100:103], 0
    ds_read_b128 v[100:103], v16 offset:56320
L_pad1:
    s_cbranch_vccnz L_pad2
    s_waitcnt lgkmcnt(4)
    v_mfma_f32_16x16x32_bf16 v[208:211], v[24:27], v[104:107], 0
    v_cvt_pk_bf16_f32 v57, v58, v59
    v_cvt_pk_bf16_f32 v60, v60, v61
    v_mfma_f32_16x16x32_bf16 v[212:215], v[28:31], v[104:107], 0
    ds_read_b128 v[104:107], v16 offset:57344
    v_cvt_pk_bf16_f32 v61, v62, v63
    v_mfma_f32_16x16x32_bf16 v[220:223], v[28:31], v[108:111], 0
    v_cvt_pk_bf16_f32 v58, v64, v65
    v_cvt_pk_bf16_f32 v59, v66, v67
    v_mfma_f32_16x16x32_bf16 v[216:219], v[24:27], v[108:111], 0
    ds_read_b128 v[108:111], v16 offset:59392
    s_waitcnt lgkmcnt(4)
    v_mfma_f32_16x16x32_bf16 v[192:195], v[40:43], v[88:91], v[192:195]
    v_cvt_pk_bf16_f32 v62, v68, v69
    v_cvt_pk_bf16_f32 v63, v70, v71
    v_mfma_f32_16x16x32_bf16 v[196:199], v[44:47], v[88:91], v[196:199]
    ds_read_b128 v[88:91], v16 offset:61440
    v_cvt_pk_bf16_f32 v72, v72, v73
    v_mfma_f32_16x16x32_bf16 v[204:207], v[44:47], v[92:95], v[204:207]
    v_cvt_pk_bf16_f32 v73, v74, v75
    v_cvt_pk_bf16_f32 v76, v76, v77
    v_mfma_f32_16x16x32_bf16 v[200:203], v[40:43], v[92:95], v[200:203]
    ds_read_b128 v[92:95], v16 offset:63488
    s_waitcnt lgkmcnt(4)
    v_mfma_f32_16x16x32_bf16 v[208:211], v[40:43], v[96:99], v[208:211]
    v_cvt_pk_bf16_f32 v77, v78, v79
    v_cvt_pk_bf16_f32 v74, v80, v81
    v_mfma_f32_16x16x32_bf16 v[212:215], v[44:47], v[96:99], v[212:215]
    ds_read_b128 v[96:99], v16 offset:58368
    v_cvt_pk_bf16_f32 v75, v82, v83
    v_mfma_f32_16x16x32_bf16 v[220:223], v[44:47], v[100:103], v[220:223]
    v_cvt_pk_bf16_f32 v78, v84, v85
    v_cvt_pk_bf16_f32 v79, v86, v87
    v_mfma_f32_16x16x32_bf16 v[216:219], v[40:43], v[100:103], v[216:219]
    ds_read_b128 v[100:103], v16 offset:60416
    s_waitcnt lgkmcnt(4)
    v_mfma_f32_16x16x32_bf16 v[224:227], v[56:59], v[104:107], 0
    v_mfma_f32_16x16x32_bf16 v[228:231], v[60:63], v[104:107], 0
    ds_read_b128 v[104:107], v16 offset:62464
    v_mfma_f32_16x16x32_bf16 v[236:239], v[60:63], v[108:111], 0
    v_mfma_f32_16x16x32_bf16 v[232:235], v[56:59], v[108:111], 0
    ds_read_b128 v[108:111], v16 offset:64512
    s_waitcnt vmcnt(0)
    s_barrier
    s_waitcnt lgkmcnt(4)
    v_mfma_f32_16x16x32_bf16 v[240:243], v[56:59], v[88:91], 0
    ds_read_b64_tr_b16 v[112:113], v8 offset:32768
    v_mfma_f32_16x16x32_bf16 v[244:247], v[60:63], v[88:91], 0
    ds_read_b128 v[88:91], v4 offset:32768
    v_mfma_f32_16x16x32_bf16 v[252:255], v[60:63], v[92:95], 0
    ds_read_b64_tr_b16 v[114:115], v12 offset:33792
    v_mfma_f32_16x16x32_bf16 v[248:251], v[56:59], v[92:95], 0
    ds_read_b128 v[92:95], v4 offset:34816
    s_waitcnt lgkmcnt(6)
    v_mfma_f32_16x16x32_bf16 v[224:227], v[72:75], v[96:99], v[224:227]
    ds_read_b64_tr_b16 v[116:117], v9 offset:32768
    v_mfma_f32_16x16x32_bf16 v[228:231], v[76:79], v[96:99], v[228:231]
    ds_read_b128 v[96:99], v4 offset:36864
    v_mfma_f32_16x16x32_bf16 v[236:239], v[76:79], v[100:103], v[236:239]
    ds_read_b64_tr_b16 v[118:119], v13 offset:33792
    v_mfma_f32_16x16x32_bf16 v[232:235], v[72:75], v[100:103], v[232:235]
    ds_read_b128 v[100:103], v4 offset:38912
    s_waitcnt lgkmcnt(8)
    v_mfma_f32_16x16x32_bf16 v[240:243], v[72:75], v[104:107], v[240:243]
    v_mfma_f32_16x16x32_bf16 v[244:247], v[76:79], v[104:107], v[244:247]
    ds_read_b128 v[104:107], v4 offset:40960
    v_mfma_f32_16x16x32_bf16 v[252:255], v[76:79], v[108:111], v[252:255]
    v_mfma_f32_16x16x32_bf16 v[248:251], v[72:75], v[108:111], v[248:251]
    ds_read_b128 v[108:111], v4 offset:43008
    s_waitcnt lgkmcnt(6)
    v_mfma_f32_16x16x32_bf16 v[24:27], v[88:91], v[112:115], 0
    s_waitcnt lgkmcnt(3)
    v_mfma_f32_16x16x32_bf16 v[28:31], v[88:91], v[116:119], 0
    ds_read_b128 v[88:91], v4 offset:45056
    v_mfma_f32_16x16x32_bf16 v[36:39], v[92:95], v[116:119], 0
    v_mfma_f32_16x16x32_bf16 v[32:35], v[92:95], v[112:115], 0
    ds_read_b128 v[92:95], v4 offset:47104
    s_waitcnt lgkmcnt(4)
    v_mfma_f32_16x16x32_bf16 v[40:43], v[96:99], v[112:115], 0
    ds_read_b64_tr_b16 v[120:121], v8 offset:40960
    v_mfma_f32_16x16x32_bf16 v[44:47], v[96:99], v[116:119], 0
    ds_read_b128 v[96:99], v5 offset:32768
    v_mfma_f32_16x16x32_bf16 v[52:55], v[100:103], v[116:119], 0
    ds_read_b64_tr_b16 v[122:123], v12 offset:41984
    v_mfma_f32_16x16x32_bf16 v[48:51], v[100:103], v[112:115], 0
    ds_read_b128 v[100:103], v5 offset:34816
    s_waitcnt lgkmcnt(6)
    v_mfma_f32_16x16x32_bf16 v[56:59], v[104:107], v[112:115], 0
    ds_read_b64_tr_b16 v[124:125], v9 offset:40960
    v_mfma_f32_16x16x32_bf16 v[60:63], v[104:107], v[116:119], 0
    ds_read_b128 v[104:107], v5 offset:36864
    v_mfma_f32_16x16x32_bf16 v[68:71], v[108:111], v[116:119], 0
    ds_read_b64_tr_b16 v[126:127], v13 offset:41984
    v_mfma_f32_16x16x32_bf16 v[64:67], v[108:111], v[112:115], 0
    ds_read_b128 v[108:111], v5 offset:38912
    s_waitcnt lgkmcnt(8)
    v_mfma_f32_16x16x32_bf16 v[72:75], v[88:91], v[112:115], 0
    v_mfma_f32_16x16x32_bf16 v[76:79], v[88:91], v[116:119], 0
    ds_read_b128 v[88:91], v5 offset:40960
    v_mfma_f32_16x16x32_bf16 v[84:87], v[92:95], v[116:119], 0
    v_mfma_f32_16x16x32_bf16 v[80:83], v[92:95], v[112:115], 0
    ds_read_b128 v[92:95], v5 offset:43008
    s_waitcnt lgkmcnt(6)
    v_mfma_f32_16x16x32_bf16 v[24:27], v[96:99], v[120:123], v[24:27]
    s_waitcnt lgkmcnt(3)
    v_mfma_f32_16x16x32_bf16 v[28:31], v[96:99], v[124:127], v[28:31]
    ds_read_b128 v[96:99], v5 offset:45056
    v_mfma_f32_16x16x32_bf16 v[36:39], v[100:103], v[124:127], v[36:39]
    s_barrier
    v_mfma_f32_16x16x32_bf16 v[32:35], v[100:103], v[120:123], v[32:35]
    ds_read_b128 v[100:103], v5 offset:47104
    s_waitcnt lgkmcnt(4)
    v_mfma_f32_16x16x32_bf16 v[40:43], v[104:107], v[120:123], v[40:43]
    ds_read_b64_tr_b16 v[112:113], v8 offset:49152
    v_mfma_f32_16x16x32_bf16 v[44:47], v[104:107], v[124:127], v[44:47]
    ds_read_b128 v[104:107], v6 offset:0
    v_mfma_f32_16x16x32_bf16 v[52:55], v[108:111], v[124:127], v[52:55]
    ds_read_b64_tr_b16 v[114:115], v12 offset:50176
    v_mfma_f32_16x16x32_bf16 v[48:51], v[108:111], v[120:123], v[48:51]
    ds_read_b128 v[108:111], v6 offset:2048
    s_waitcnt lgkmcnt(6)
    v_mfma_f32_16x16x32_bf16 v[56:59], v[88:91], v[120:123], v[56:59]
    ds_read_b64_tr_b16 v[116:117], v9 offset:49152
    v_mfma_f32_16x16x32_bf16 v[60:63], v[88:91], v[124:127], v[60:63]
    ds_read_b128 v[88:91], v6 offset:4096
    v_mfma_f32_16x16x32_bf16 v[68:71], v[92:95], v[124:127], v[68:71]
    ds_read_b64_tr_b16 v[118:119], v13 offset:50176
    v_mfma_f32_16x16x32_bf16 v[64:67], v[92:95], v[120:123], v[64:67]
    ds_read_b128 v[92:95], v6 offset:6144
    s_waitcnt lgkmcnt(8)
    v_mfma_f32_16x16x32_bf16 v[72:75], v[96:99], v[120:123], v[72:75]
    v_mfma_f32_16x16x32_bf16 v[76:79], v[96:99], v[124:127], v[76:79]
    ds_read_b128 v[96:99], v6 offset:8192
    v_mfma_f32_16x16x32_bf16 v[84:87], v[100:103], v[124:127], v[84:87]
    v_mfma_f32_16x16x32_bf16 v[80:83], v[100:103], v[120:123], v[80:83]
    ds_read_b128 v[100:103], v6 offset:10240
    s_waitcnt lgkmcnt(6)
    v_mfma_f32_16x16x32_bf16 v[24:27], v[104:107], v[112:115], v[24:27]
    s_waitcnt lgkmcnt(3)
    v_mfma_f32_16x16x32_bf16 v[28:31], v[104:107], v[116:119], v[28:31]
    ds_read_b128 v[104:107], v6 offset:12288
    v_mfma_f32_16x16x32_bf16 v[36:39], v[108:111], v[116:119], v[36:39]
    v_mfma_f32_16x16x32_bf16 v[32:35], v[108:111], v[112:115], v[32:35]
    ds_read_b128 v[108:111], v6 offset:14336
    s_waitcnt lgkmcnt(4)
    v_mfma_f32_16x16x32_bf16 v[40:43], v[88:91], v[112:115], v[40:43]
    ds_read_b64_tr_b16 v[120:121], v8 offset:57344
    v_mfma_f32_16x16x32_bf16 v[44:47], v[88:91], v[116:119], v[44:47]
    ds_read_b128 v[88:91], v7 offset:0
    v_mfma_f32_16x16x32_bf16 v[52:55], v[92:95], v[116:119], v[52:55]
    ds_read_b64_tr_b16 v[122:123], v12 offset:58368
    v_mfma_f32_16x16x32_bf16 v[48:51], v[92:95], v[112:115], v[48:51]
    ds_read_b128 v[92:95], v7 offset:2048
    s_waitcnt lgkmcnt(6)
    v_mfma_f32_16x16x32_bf16 v[56:59], v[96:99], v[112:115], v[56:59]
    ds_read_b64_tr_b16 v[124:125], v9 offset:57344
    v_mfma_f32_16x16x32_bf16 v[60:63], v[96:99], v[116:119], v[60:63]
    ds_read_b128 v[96:99], v7 offset:4096
    v_mfma_f32_16x16x32_bf16 v[68:71], v[100:103], v[116:119], v[68:71]
    ds_read_b64_tr_b16 v[126:127], v13 offset:58368
    v_mfma_f32_16x16x32_bf16 v[64:67], v[100:103], v[112:115], v[64:67]
    ds_read_b128 v[100:103], v7 offset:6144
    s_waitcnt lgkmcnt(8)
    v_mfma_f32_16x16x32_bf16 v[72:75], v[104:107], v[112:115], v[72:75]
    v_mfma_f32_16x16x32_bf16 v[76:79], v[104:107], v[116:119], v[76:79]
    ds_read_b128 v[104:107], v7 offset:8192
    v_mfma_f32_16x16x32_bf16 v[84:87], v[108:111], v[116:119], v[84:87]
    v_mfma_f32_16x16x32_bf16 v[80:83], v[108:111], v[112:115], v[80:83]
    ds_read_b128 v[108:111], v7 offset:10240
    s_waitcnt lgkmcnt(6)
    v_mfma_f32_16x16x32_bf16 v[24:27], v[88:91], v[120:123], v[24:27]
    s_waitcnt lgkmcnt(3)
    v_mfma_f32_16x16x32_bf16 v[28:31], v[88:91], v[124:127], v[28:31]
    ds_read_b128 v[88:91], v7 offset:12288
    v_mfma_f32_16x16x32_bf16 v[36:39], v[92:95], v[124:127], v[36:39]
    s_barrier
    v_mfma_f32_16x16x32_bf16 v[32:35], v[92:95], v[120:123], v[32:35]
    ds_read_b128 v[92:95], v7 offset:14336
    s_waitcnt lgkmcnt(4)
    v_mfma_f32_16x16x32_bf16 v[40:43], v[96:99], v[120:123], v[40:43]
    ds_read_b64_tr_b16 v[112:113], v8 offset:0
    v_mfma_f32_16x16x32_bf16 v[44:47], v[96:99], v[124:127], v[44:47]
    ds_read_b128 v[96:99], v6 offset:16384
    v_mfma_f32_16x16x32_bf16 v[52:55], v[100:103], v[124:127], v[52:55]
    ds_read_b64_tr_b16 v[114:115], v12 offset:1024
    v_cvt_pk_bf16_f32 v128, v24, v25
    v_mfma_f32_16x16x32_bf16 v[48:51], v[100:103], v[120:123], v[48:51]
    ds_read_b128 v[100:103], v6 offset:18432
    s_waitcnt lgkmcnt(6)
    v_mfma_f32_16x16x32_bf16 v[56:59], v[104:107], v[120:123], v[56:59]
    ds_read_b64_tr_b16 v[116:117], v9 offset:0
    v_cvt_pk_bf16_f32 v129, v26, v27
    v_mfma_f32_16x16x32_bf16 v[60:63], v[104:107], v[124:127], v[60:63]
    ds_read_b128 v[104:107], v6 offset:20480
    v_cvt_pk_bf16_f32 v132, v28, v29
    v_mfma_f32_16x16x32_bf16 v[68:71], v[108:111], v[124:127], v[68:71]
    ds_read_b64_tr_b16 v[118:119], v13 offset:1024
    v_cvt_pk_bf16_f32 v133, v30, v31
    v_mfma_f32_16x16x32_bf16 v[64:67], v[108:111], v[120:123], v[64:67]
    ds_read_b128 v[108:111], v6 offset:22528
    s_waitcnt lgkmcnt(8)
    v_mfma_f32_16x16x32_bf16 v[72:75], v[88:91], v[120:123], v[72:75]
    v_cvt_pk_bf16_f32 v130, v32, v33
    v_cvt_pk_bf16_f32 v131, v34, v35
    v_mfma_f32_16x16x32_bf16 v[76:79], v[88:91], v[124:127], v[76:79]
    ds_read_b128 v[88:91], v6 offset:24576
    v_cvt_pk_bf16_f32 v134, v36, v37
    v_mfma_f32_16x16x32_bf16 v[84:87], v[92:95], v[124:127], v[84:87]
    v_cvt_pk_bf16_f32 v135, v38, v39
    v_cvt_pk_bf16_f32 v136, v40, v41
    v_mfma_f32_16x16x32_bf16 v[80:83], v[92:95], v[120:123], v[80:83]
    ds_read_b128 v[92:95], v6 offset:26624
    v_cvt_pk_bf16_f32 v137, v42, v43
    s_waitcnt lgkmcnt(6)
    v_mfma_f32_16x16x32_bf16 v[24:27], v[96:99], v[112:115], 0
    v_cvt_pk_bf16_f32 v140, v44, v45
    v_cvt_pk_bf16_f32 v141, v46, v47
    v_cvt_pk_bf16_f32 v138, v48, v49
    s_waitcnt lgkmcnt(3)
    v_mfma_f32_16x16x32_bf16 v[28:31], v[96:99], v[116:119], 0
    ds_read_b128 v[96:99], v6 offset:28672
    v_cvt_pk_bf16_f32 v139, v50, v51
    v_mfma_f32_16x16x32_bf16 v[36:39], v[100:103], v[116:119], 0
    v_cvt_pk_bf16_f32 v142, v52, v53
    v_cvt_pk_bf16_f32 v143, v54, v55
    v_mfma_f32_16x16x32_bf16 v[32:35], v[100:103], v[112:115], 0
    ds_read_b128 v[100:103], v6 offset:30720
    v_cvt_pk_bf16_f32 v144, v56, v57
    s_waitcnt lgkmcnt(4)
    v_mfma_f32_16x16x32_bf16 v[40:43], v[104:107], v[112:115], 0
    ds_read_b64_tr_b16 v[120:121], v8 offset:8192
    v_cvt_pk_bf16_f32 v145, v58, v59
    v_cvt_pk_bf16_f32 v148, v60, v61
    v_mfma_f32_16x16x32_bf16 v[44:47], v[104:107], v[116:119], 0
    ds_read_b128 v[104:107], v7 offset:16384
    v_cvt_pk_bf16_f32 v149, v62, v63
    v_mfma_f32_16x16x32_bf16 v[52:55], v[108:111], v[116:119], 0
    ds_read_b64_tr_b16 v[122:123], v12 offset:9216
    v_cvt_pk_bf16_f32 v146, v64, v65
    v_mfma_f32_16x16x32_bf16 v[48:51], v[108:111], v[112:115], 0
    ds_read_b128 v[108:111], v7 offset:18432
    v_cvt_pk_bf16_f32 v147, v66, v67
    s_waitcnt lgkmcnt(6)
    v_mfma_f32_16x16x32_bf16 v[56:59], v[88:91], v[112:115], 0
    ds_read_b64_tr_b16 v[124:125], v9 offset:8192
    v_cvt_pk_bf16_f32 v150, v68, v69
    v_cvt_pk_bf16_f32 v151, v70, v71
    v_mfma_f32_16x16x32_bf16 v[60:63], v[88:91], v[116:119], 0
    ds_read_b128 v[88:91], v7 offset:20480
    v_cvt_pk_bf16_f32 v152, v72, v73
    v_mfma_f32_16x16x32_bf16 v[68:71], v[92:95], v[116:119], 0
    ds_read_b64_tr_b16 v[126:127], v13 offset:9216
    v_cvt_pk_bf16_f32 v153, v74, v75
    v_cvt_pk_bf16_f32 v156, v76, v77
    v_mfma_f32_16x16x32_bf16 v[64:67], v[92:95], v[112:115], 0
    ds_read_b128 v[92:95], v7 offset:22528
    v_cvt_pk_bf16_f32 v157, v78, v79
    s_waitcnt lgkmcnt(8)
    v_mfma_f32_16x16x32_bf16 v[72:75], v[96:99], v[112:115], 0
    v_cvt_pk_bf16_f32 v154, v80, v81
    v_cvt_pk_bf16_f32 v155, v82, v83
    v_mfma_f32_16x16x32_bf16 v[76:79], v[96:99], v[116:119], 0
    ds_read_b128 v[96:99], v7 offset:24576
    v_cvt_pk_bf16_f32 v158, v84, v85
    v_cvt_pk_bf16_f32 v159, v86, v87
    v_mfma_f32_16x16x32_bf16 v[84:87], v[100:103], v[116:119], 0
    v_mfma_f32_16x16x32_bf16 v[80:83], v[100:103], v[112:115], 0
    ds_read_b128 v[100:103], v7 offset:26624
    s_waitcnt lgkmcnt(6)
    v_mfma_f32_16x16x32_bf16 v[24:27], v[104:107], v[120:123], v[24:27]
    s_waitcnt lgkmcnt(3)
    v_mfma_f32_16x16x32_bf16 v[28:31], v[104:107], v[124:127], v[28:31]
    ds_read_b128 v[104:107], v7 offset:28672
    v_mfma_f32_16x16x32_bf16 v[36:39], v[108:111], v[124:127], v[36:39]
    s_barrier
    v_mfma_f32_16x16x32_bf16 v[32:35], v[108:111], v[120:123], v[32:35]
    ds_read_b128 v[108:111], v7 offset:30720
    s_waitcnt lgkmcnt(4)
    v_mfma_f32_16x16x32_bf16 v[40:43], v[88:91], v[120:123], v[40:43]
    ds_read_b64_tr_b16 v[112:113], v8 offset:16384
    v_mfma_f32_16x16x32_bf16 v[44:47], v[88:91], v[124:127], v[44:47]
    ds_read_b128 v[88:91], v4 offset:0
    v_mfma_f32_16x16x32_bf16 v[52:55], v[92:95], v[124:127], v[52:55]
    ds_read_b64_tr_b16 v[114:115], v12 offset:17408
    v_mfma_f32_16x16x32_bf16 v[48:51], v[92:95], v[120:123], v[48:51]
    ds_read_b128 v[92:95], v4 offset:2048
    s_waitcnt lgkmcnt(6)
    v_mfma_f32_16x16x32_bf16 v[56:59], v[96:99], v[120:123], v[56:59]
    ds_read_b64_tr_b16 v[116:117], v9 offset:16384
    v_mfma_f32_16x16x32_bf16 v[60:63], v[96:99], v[124:127], v[60:63]
    ds_read_b128 v[96:99], v4 offset:4096
    v_mfma_f32_16x16x32_bf16 v[68:71], v[100:103], v[124:127], v[68:71]
    ds_read_b64_tr_b16 v[118:119], v13 offset:17408
    v_mfma_f32_16x16x32_bf16 v[64:67], v[100:103], v[120:123], v[64:67]
    ds_read_b128 v[100:103], v4 offset:6144
    s_waitcnt lgkmcnt(8)
    v_mfma_f32_16x16x32_bf16 v[72:75], v[104:107], v[120:123], v[72:75]
    v_mfma_f32_16x16x32_bf16 v[76:79], v[104:107], v[124:127], v[76:79]
    ds_read_b128 v[104:107], v4 offset:8192
    v_mfma_f32_16x16x32_bf16 v[84:87], v[108:111], v[124:127], v[84:87]
    v_mfma_f32_16x16x32_bf16 v[80:83], v[108:111], v[120:123], v[80:83]
    ds_read_b128 v[108:111], v4 offset:10240
    s_waitcnt lgkmcnt(6)
    v_mfma_f32_16x16x32_bf16 v[24:27], v[88:91], v[112:115], v[24:27]
    s_waitcnt lgkmcnt(3)
    v_mfma_f32_16x16x32_bf16 v[28:31], v[88:91], v[116:119], v[28:31]
    ds_read_b128 v[88:91], v4 offset:12288
    v_mfma_f32_16x16x32_bf16 v[36:39], v[92:95], v[116:119], v[36:39]
    v_mfma_f32_16x16x32_bf16 v[32:35], v[92:95], v[112:115], v[32:35]
    ds_read_b128 v[92:95], v4 offset:14336
    s_waitcnt lgkmcnt(4)
    v_mfma_f32_16x16x32_bf16 v[40:43], v[96:99], v[112:115], v[40:43]
    ds_read_b64_tr_b16 v[120:121], v8 offset:24576
    v_mfma_f32_16x16x32_bf16 v[44:47], v[96:99], v[116:119], v[44:47]
    ds_read_b128 v[96:99], v5 offset:0
    v_mfma_f32_16x16x32_bf16 v[52:55], v[100:103], v[116:119], v[52:55]
    ds_read_b64_tr_b16 v[122:123], v12 offset:25600
    v_mfma_f32_16x16x32_bf16 v[48:51], v[100:103], v[112:115], v[48:51]
    ds_read_b128 v[100:103], v5 offset:2048
    s_waitcnt lgkmcnt(6)
    v_mfma_f32_16x16x32_bf16 v[56:59], v[104:107], v[112:115], v[56:59]
    ds_read_b64_tr_b16 v[124:125], v9 offset:24576
    v_mfma_f32_16x16x32_bf16 v[60:63], v[104:107], v[116:119], v[60:63]
    ds_read_b128 v[104:107], v5 offset:4096
    v_mfma_f32_16x16x32_bf16 v[68:71], v[108:111], v[116:119], v[68:71]
    ds_read_b64_tr_b16 v[126:127], v13 offset:25600
    v_mfma_f32_16x16x32_bf16 v[64:67], v[108:111], v[112:115], v[64:67]
    ds_read_b128 v[108:111], v5 offset:6144
    s_waitcnt lgkmcnt(8)
    v_mfma_f32_16x16x32_bf16 v[72:75], v[88:91], v[112:115], v[72:75]
    v_mfma_f32_16x16x32_bf16 v[76:79], v[88:91], v[116:119], v[76:79]
    ds_read_b128 v[88:91], v5 offset:8192
    v_mfma_f32_16x16x32_bf16 v[84:87], v[92:95], v[116:119], v[84:87]
    v_mfma_f32_16x16x32_bf16 v[80:83], v[92:95], v[112:115], v[80:83]
    ds_read_b128 v[92:95], v5 offset:10240
    s_waitcnt lgkmcnt(6)
    v_mfma_f32_16x16x32_bf16 v[24:27], v[96:99], v[120:123], v[24:27]
    s_waitcnt lgkmcnt(3)
    v_mfma_f32_16x16x32_bf16 v[28:31], v[96:99], v[124:127], v[28:31]
    ds_read_b128 v[96:99], v5 offset:12288
    v_mfma_f32_16x16x32_bf16 v[36:39], v[100:103], v[124:127], v[36:39]
    s_barrier
    v_mfma_f32_16x16x32_bf16 v[32:35], v[100:103], v[120:123], v[32:35]
    ds_read_b128 v[100:103], v5 offset:14336
    s_waitcnt lgkmcnt(4)
    v_mfma_f32_16x16x32_bf16 v[40:43], v[104:107], v[120:123], v[40:43]
    ds_read_b64_tr_b16 v[112:113], v8 offset:32768
    v_mfma_f32_16x16x32_bf16 v[44:47], v[104:107], v[124:127], v[44:47]
    ds_read_b128 v[104:107], v4 offset:16384
    v_mfma_f32_16x16x32_bf16 v[52:55], v[108:111], v[124:127], v[52:55]
    ds_read_b64_tr_b16 v[114:115], v12 offset:33792
    v_cvt_pk_bf16_f32 v160, v24, v25
    v_mfma_f32_16x16x32_bf16 v[48:51], v[108:111], v[120:123], v[48:51]
    ds_read_b128 v[108:111], v4 offset:18432
    s_waitcnt lgkmcnt(6)
    v_mfma_f32_16x16x32_bf16 v[56:59], v[88:91], v[120:123], v[56:59]
    ds_read_b64_tr_b16 v[116:117], v9 offset:32768
    v_cvt_pk_bf16_f32 v161, v26, v27
    v_mfma_f32_16x16x32_bf16 v[60:63], v[88:91], v[124:127], v[60:63]
    ds_read_b128 v[88:91], v4 offset:20480
    v_cvt_pk_bf16_f32 v164, v28, v29
    v_mfma_f32_16x16x32_bf16 v[68:71], v[92:95], v[124:127], v[68:71]
    ds_read_b64_tr_b16 v[118:119], v13 offset:33792
    v_cvt_pk_bf16_f32 v165, v30, v31
    v_mfma_f32_16x16x32_bf16 v[64:67], v[92:95], v[120:123], v[64:67]
    ds_read_b128 v[92:95], v4 offset:22528
    s_waitcnt lgkmcnt(8)
    v_mfma_f32_16x16x32_bf16 v[72:75], v[96:99], v[120:123], v[72:75]
    v_cvt_pk_bf16_f32 v162, v32, v33
    v_cvt_pk_bf16_f32 v163, v34, v35
    v_mfma_f32_16x16x32_bf16 v[76:79], v[96:99], v[124:127], v[76:79]
    ds_read_b128 v[96:99], v4 offset:24576
    v_cvt_pk_bf16_f32 v166, v36, v37
    v_mfma_f32_16x16x32_bf16 v[84:87], v[100:103], v[124:127], v[84:87]
    v_cvt_pk_bf16_f32 v167, v38, v39
    v_cvt_pk_bf16_f32 v168, v40, v41
    v_mfma_f32_16x16x32_bf16 v[80:83], v[100:103], v[120:123], v[80:83]
    ds_read_b128 v[100:103], v4 offset:26624
    v_cvt_pk_bf16_f32 v169, v42, v43
    s_waitcnt lgkmcnt(6)
    v_mfma_f32_16x16x32_bf16 v[24:27], v[104:107], v[112:115], 0
    v_cvt_pk_bf16_f32 v172, v44, v45
    v_cvt_pk_bf16_f32 v173, v46, v47
    v_cvt_pk_bf16_f32 v170, v48, v49
    s_waitcnt lgkmcnt(3)
    v_mfma_f32_16x16x32_bf16 v[28:31], v[104:107], v[116:119], 0
    ds_read_b128 v[104:107], v4 offset:28672
    v_cvt_pk_bf16_f32 v171, v50, v51
    v_mfma_f32_16x16x32_bf16 v[36:39], v[108:111], v[116:119], 0
    v_cvt_pk_bf16_f32 v174, v52, v53
    v_cvt_pk_bf16_f32 v175, v54, v55
    v_mfma_f32_16x16x32_bf16 v[32:35], v[108:111], v[112:115], 0
    ds_read_b128 v[108:111], v4 offset:30720
    v_cvt_pk_bf16_f32 v176, v56, v57
    s_waitcnt lgkmcnt(4)
    v_mfma_f32_16x16x32_bf16 v[40:43], v[88:91], v[112:115], 0
    ds_read_b64_tr_b16 v[120:121], v8 offset:40960
    v_cvt_pk_bf16_f32 v177, v58, v59
    v_cvt_pk_bf16_f32 v180, v60, v61
    v_mfma_f32_16x16x32_bf16 v[44:47], v[88:91], v[116:119], 0
    ds_read_b128 v[88:91], v5 offset:16384
    v_cvt_pk_bf16_f32 v181, v62, v63
    v_mfma_f32_16x16x32_bf16 v[52:55], v[92:95], v[116:119], 0
    ds_read_b64_tr_b16 v[122:123], v12 offset:41984
    v_cvt_pk_bf16_f32 v178, v64, v65
    v_mfma_f32_16x16x32_bf16 v[48:51], v[92:95], v[112:115], 0
    ds_read_b128 v[92:95], v5 offset:18432
    v_cvt_pk_bf16_f32 v179, v66, v67
    s_waitcnt lgkmcnt(6)
    v_mfma_f32_16x16x32_bf16 v[56:59], v[96:99], v[112:115], 0
    ds_read_b64_tr_b16 v[124:125], v9 offset:40960
    v_cvt_pk_bf16_f32 v182, v68, v69
    v_cvt_pk_bf16_f32 v183, v70, v71
    v_mfma_f32_16x16x32_bf16 v[60:63], v[96:99], v[116:119], 0
    ds_read_b128 v[96:99], v5 offset:20480
    v_cvt_pk_bf16_f32 v184, v72, v73
    v_mfma_f32_16x16x32_bf16 v[68:71], v[100:103], v[116:119], 0
    ds_read_b64_tr_b16 v[126:127], v13 offset:41984
    v_cvt_pk_bf16_f32 v185, v74, v75
    v_cvt_pk_bf16_f32 v188, v76, v77
    v_mfma_f32_16x16x32_bf16 v[64:67], v[100:103], v[112:115], 0
    ds_read_b128 v[100:103], v5 offset:22528
    v_cvt_pk_bf16_f32 v189, v78, v79
    s_waitcnt lgkmcnt(8)
    v_mfma_f32_16x16x32_bf16 v[72:75], v[104:107], v[112:115], 0
    v_cvt_pk_bf16_f32 v186, v80, v81
    v_cvt_pk_bf16_f32 v187, v82, v83
    v_mfma_f32_16x16x32_bf16 v[76:79], v[104:107], v[116:119], 0
    ds_read_b128 v[104:107], v5 offset:24576
    v_cvt_pk_bf16_f32 v190, v84, v85
    v_cvt_pk_bf16_f32 v191, v86, v87
    v_mfma_f32_16x16x32_bf16 v[84:87], v[108:111], v[116:119], 0
    v_mfma_f32_16x16x32_bf16 v[80:83], v[108:111], v[112:115], 0
    ds_read_b128 v[108:111], v5 offset:26624
    s_waitcnt lgkmcnt(6)
    v_mfma_f32_16x16x32_bf16 v[24:27], v[88:91], v[120:123], v[24:27]
    s_waitcnt lgkmcnt(3)
    v_mfma_f32_16x16x32_bf16 v[28:31], v[88:91], v[124:127], v[28:31]
    ds_read_b128 v[88:91], v5 offset:28672
    v_mfma_f32_16x16x32_bf16 v[36:39], v[92:95], v[124:127], v[36:39]
    s_barrier
    v_mfma_f32_16x16x32_bf16 v[32:35], v[92:95], v[120:123], v[32:35]
    ds_read_b128 v[92:95], v5 offset:30720
    s_waitcnt lgkmcnt(4)
    v_mfma_f32_16x16x32_bf16 v[40:43], v[96:99], v[120:123], v[40:43]
    ds_read_b64_tr_b16 v[112:113], v8 offset:49152
    v_mfma_f32_16x16x32_bf16 v[44:47], v[96:99], v[124:127], v[44:47]
    ds_read_b128 v[96:99], v4 offset:32768
    v_mfma_f32_16x16x32_bf16 v[52:55], v[100:103], v[124:127], v[52:55]
    ds_read_b64_tr_b16 v[114:115], v12 offset:50176
    v_mfma_f32_16x16x32_bf16 v[48:51], v[100:103], v[120:123], v[48:51]
    ds_read_b128 v[100:103], v4 offset:34816
    s_waitcnt lgkmcnt(6)
    v_mfma_f32_16x16x32_bf16 v[56:59], v[104:107], v[120:123], v[56:59]
    ds_read_b64_tr_b16 v[116:117], v9 offset:49152
    v_mfma_f32_16x16x32_bf16 v[60:63], v[104:107], v[124:127], v[60:63]
    ds_read_b128 v[104:107], v4 offset:36864
    v_mfma_f32_16x16x32_bf16 v[68:71], v[108:111], v[124:127], v[68:71]
    ds_read_b64_tr_b16 v[118:119], v13 offset:50176
    v_mfma_f32_16x16x32_bf16 v[64:67], v[108:111], v[120:123], v[64:67]
    ds_read_b128 v[108:111], v4 offset:38912
    s_waitcnt lgkmcnt(8)
    v_mfma_f32_16x16x32_bf16 v[72:75], v[88:91], v[120:123], v[72:75]
    v_mfma_f32_16x16x32_bf16 v[76:79], v[88:91], v[124:127], v[76:79]
    ds_read_b128 v[88:91], v4 offset:40960
    v_mfma_f32_16x16x32_bf16 v[84:87], v[92:95], v[124:127], v[84:87]
    v_mfma_f32_16x16x32_bf16 v[80:83], v[92:95], v[120:123], v[80:83]
    ds_read_b128 v[92:95], v4 offset:43008
    s_waitcnt lgkmcnt(6)
    v_mfma_f32_16x16x32_bf16 v[24:27], v[96:99], v[112:115], v[24:27]
    s_waitcnt lgkmcnt(3)
    v_mfma_f32_16x16x32_bf16 v[28:31], v[96:99], v[116:119], v[28:31]
    ds_read_b128 v[96:99], v4 offset:45056
    v_mfma_f32_16x16x32_bf16 v[36:39], v[100:103], v[116:119], v[36:39]
    v_mfma_f32_16x16x32_bf16 v[32:35], v[100:103], v[112:115], v[32:35]
    ds_read_b128 v[100:103], v4 offset:47104
    s_waitcnt lgkmcnt(4)
    v_mfma_f32_16x16x32_bf16 v[40:43], v[104:107], v[112:115], v[40:43]
    ds_read_b64_tr_b16 v[120:121], v8 offset:57344
    v_mfma_f32_16x16x32_bf16 v[44:47], v[104:107], v[116:119], v[44:47]
    ds_read_b128 v[104:107], v5 offset:32768
    v_mfma_f32_16x16x32_bf16 v[52:55], v[108:111], v[116:119], v[52:55]
    ds_read_b64_tr_b16 v[122:123], v12 offset:58368
    v_mfma_f32_16x16x32_bf16 v[48:51], v[108:111], v[112:115], v[48:51]
    ds_read_b128 v[108:111], v5 offset:34816
    s_waitcnt lgkmcnt(6)
    v_mfma_f32_16x16x32_bf16 v[56:59], v[88:91], v[112:115], v[56:59]
    ds_read_b64_tr_b16 v[124:125], v9 offset:57344
    v_mfma_f32_16x16x32_bf16 v[60:63], v[88:91], v[116:119], v[60:63]
    ds_read_b128 v[88:91], v5 offset:36864
    v_mfma_f32_16x16x32_bf16 v[68:71], v[92:95], v[116:119], v[68:71]
    ds_read_b64_tr_b16 v[126:127], v13 offset:58368
    v_mfma_f32_16x16x32_bf16 v[64:67], v[92:95], v[112:115], v[64:67]
    ds_read_b128 v[92:95], v5 offset:38912
    s_waitcnt lgkmcnt(8)
    v_mfma_f32_16x16x32_bf16 v[72:75], v[96:99], v[112:115], v[72:75]
    v_mfma_f32_16x16x32_bf16 v[76:79], v[96:99], v[116:119], v[76:79]
    ds_read_b128 v[96:99], v5 offset:40960
    v_mfma_f32_16x16x32_bf16 v[84:87], v[100:103], v[116:119], v[84:87]
    v_mfma_f32_16x16x32_bf16 v[80:83], v[100:103], v[112:115], v[80:83]
    ds_read_b128 v[100:103], v5 offset:43008
    s_waitcnt lgkmcnt(6)
    v_mfma_f32_16x16x32_bf16 v[24:27], v[104:107], v[120:123], v[24:27]
    s_waitcnt lgkmcnt(3)
    v_mfma_f32_16x16x32_bf16 v[28:31], v[104:107], v[124:127], v[28:31]
    ds_read_b128 v[104:107], v5 offset:45056
    v_mfma_f32_16x16x32_bf16 v[36:39], v[108:111], v[124:127], v[36:39]
    v_mfma_f32_16x16x32_bf16 v[32:35], v[108:111], v[120:123], v[32:35]
    ds_read_b128 v[108:111], v5 offset:47104
    s_waitcnt lgkmcnt(4)
    v_mfma_f32_16x16x32_bf16 v[40:43], v[88:91], v[120:123], v[40:43]
    s_barrier
    v_mfma_f32_16x16x32_bf16 v[44:47], v[88:91], v[124:127], v[44:47]
    ds_read_b128 v[88:91], v11 offset:0
    v_mfma_f32_16x16x32_bf16 v[52:55], v[92:95], v[124:127], v[52:55]
    v_cvt_pk_bf16_f32 v24, v24, v25
    v_cvt_pk_bf16_f32 v25, v26, v27
    v_mfma_f32_16x16x32_bf16 v[48:51], v[92:95], v[120:123], v[48:51]
    ds_read_b128 v[92:95], v11 offset:1024
    s_waitcnt lgkmcnt(4)
    v_mfma_f32_16x16x32_bf16 v[56:59], v[96:99], v[120:123], v[56:59]
    v_cvt_pk_bf16_f32 v28, v28, v29
    v_cvt_pk_bf16_f32 v29, v30, v31
    v_mfma_f32_16x16x32_bf16 v[60:63], v[96:99], v[124:127], v[60:63]
    ds_read_b128 v[96:99], v11 offset:16384
    v_cvt_pk_bf16_f32 v26, v32, v33
    v_mfma_f32_16x16x32_bf16 v[68:71], v[100:103], v[124:127], v[68:71]
    v_cvt_pk_bf16_f32 v27, v34, v35
    v_cvt_pk_bf16_f32 v30, v36, v37
    v_mfma_f32_16x16x32_bf16 v[64:67], v[100:103], v[120:123], v[64:67]
    ds_read_b128 v[100:103], v11 offset:17408
    s_waitcnt lgkmcnt(4)
    v_mfma_f32_16x16x32_bf16 v[72:75], v[104:107], v[120:123], v[72:75]
    v_cvt_pk_bf16_f32 v31, v38, v39
    v_cvt_pk_bf16_f32 v40, v40, v41
    v_mfma_f32_16x16x32_bf16 v[76:79], v[104:107], v[124:127], v[76:79]
    ds_read_b128 v[104:107], v10 offset:0
    v_cvt_pk_bf16_f32 v41, v42, v43
    v_mfma_f32_16x16x32_bf16 v[84:87], v[108:111], v[124:127], v[84:87]
    v_cvt_pk_bf16_f32 v44, v44, v45
    v_cvt_pk_bf16_f32 v45, v46, v47
    v_mfma_f32_16x16x32_bf16 v[80:83], v[108:111], v[120:123], v[80:83]
    ds_read_b128 v[108:111], v10 offset:1024
    s_waitcnt lgkmcnt(4)
    v_mfma_f32_16x16x32_bf16 v[192:195], v[128:131], v[88:91], v[192:195]
    v_cvt_pk_bf16_f32 v42, v48, v49
    v_cvt_pk_bf16_f32 v43, v50, v51
    v_mfma_f32_16x16x32_bf16 v[196:199], v[132:135], v[88:91], v[196:199]
L_pad2:
    s_cbranch_vccnz L_pad3
    ds_read_b128 v[88:91], v11 offset:2048
    v_cvt_pk_bf16_f32 v46, v52, v53
    v_mfma_f32_16x16x32_bf16 v[196:199], v[140:143], v[92:95], v[196:199]
    v_cvt_pk_bf16_f32 v47, v54, v55
    v_cvt_pk_bf16_f32 v56, v56, v57
    v_mfma_f32_16x16x32_bf16 v[192:195], v[136:139], v[92:95], v[192:195]
    ds_read_b128 v[92:95], v11 offset:3072
    s_waitcnt lgkmcnt(4)
    v_mfma_f32_16x16x32_bf16 v[192:195], v[160:163], v[96:99], v[192:195]
    v_cvt_pk_bf16_f32 v57, v58, v59
    v_cvt_pk_bf16_f32 v60, v60, v61
    v_mfma_f32_16x16x32_bf16 v[196:199], v[164:167], v[96:99], v[196:199]
    ds_read_b128 v[96:99], v11 offset:18432
    v_cvt_pk_bf16_f32 v61, v62, v63
    v_mfma_f32_16x16x32_bf16 v[196:199], v[172:175], v[100:103], v[196:199]
    v_cvt_pk_bf16_f32 v58, v64, v65
    v_cvt_pk_bf16_f32 v59, v66, v67
    v_mfma_f32_16x16x32_bf16 v[192:195], v[168:171], v[100:103], v[192:195]
    ds_read_b128 v[100:103], v11 offset:19456
    s_waitcnt lgkmcnt(4)
    v_mfma_f32_16x16x32_bf16 v[192:195], v[24:27], v[104:107], v[192:195]
    v_cvt_pk_bf16_f32 v62, v68, v69
    v_cvt_pk_bf16_f32 v63, v70, v71
    v_mfma_f32_16x16x32_bf16 v[196:199], v[28:31], v[104:107], v[196:199]
    ds_read_b128 v[104:107], v10 offset:2048
    v_cvt_pk_bf16_f32 v72, v72, v73
    v_mfma_f32_16x16x32_bf16 v[196:199], v[44:47], v[108:111], v[196:199]
    v_cvt_pk_bf16_f32 v73, v74, v75
    v_cvt_pk_bf16_f32 v76, v76, v77
    v_mfma_f32_16x16x32_bf16 v[192:195], v[40:43], v[108:111], v[192:195]
    ds_read_b128 v[108:111], v10 offset:3072
    s_waitcnt lgkmcnt(4)
    v_mfma_f32_16x16x32_bf16 v[200:203], v[128:131], v[88:91], v[200:203]
    v_cvt_pk_bf16_f32 v77, v78, v79
    v_cvt_pk_bf16_f32 v74, v80, v81
    v_mfma_f32_16x16x32_bf16 v[204:207], v[132:135], v[88:91], v[204:207]
    ds_read_b128 v[88:91], v11 offset:4096
    v_cvt_pk_bf16_f32 v75, v82, v83
    v_mfma_f32_16x16x32_bf16 v[204:207], v[140:143], v[92:95], v[204:207]
    v_cvt_pk_bf16_f32 v78, v84, v85
    v_cvt_pk_bf16_f32 v79, v86, v87
    v_mfma_f32_16x16x32_bf16 v[200:203], v[136:139], v[92:95], v[200:203]
    ds_read_b128 v[92:95], v11 offset:5120
    s_waitcnt lgkmcnt(4)
    v_mfma_f32_16x16x32_bf16 v[200:203], v[160:163], v[96:99], v[200:203]
    v_cvt_pk_bf16_f32 v114, v196, v197
    v_cvt_pk_bf16_f32 v115, v198, v199
    v_mfma_f32_16x16x32_bf16 v[204:207], v[164:167], v[96:99], v[204:207]
    ds_read_b128 v[96:99], v11 offset:20480
    v_mfma_f32_16x16x32_bf16 v[204:207], v[172:175], v[100:103], v[204:207]
    v_cvt_pk_bf16_f32 v112, v192, v193
    v_cvt_pk_bf16_f32 v113, v194, v195
    v_mfma_f32_16x16x32_bf16 v[200:203], v[168:171], v[100:103], v[200:203]
    ds_read_b128 v[100:103], v11 offset:21504
    s_waitcnt lgkmcnt(4)
    v_mfma_f32_16x16x32_bf16 v[200:203], v[24:27], v[104:107], v[200:203]
    buffer_store_dwordx4 v[112:115], v16, s[56:59], s80 offen sc1
    v_mfma_f32_16x16x32_bf16 v[204:207], v[28:31], v[104:107], v[204:207]
    ds_read_b128 v[104:107], v10 offset:4096
    v_mfma_f32_16x16x32_bf16 v[204:207], v[44:47], v[108:111], v[204:207]
    v_mfma_f32_16x16x32_bf16 v[200:203], v[40:43], v[108:111], v[200:203]
    ds_read_b128 v[108:111], v10 offset:5120
    s_waitcnt lgkmcnt(4)
    v_mfma_f32_16x16x32_bf16 v[208:211], v[128:131], v[88:91], v[208:211]
    v_mfma_f32_16x16x32_bf16 v[212:215], v[132:135], v[88:91], v[212:215]
    ds_read_b128 v[88:91], v11 offset:6144
    v_mfma_f32_16x16x32_bf16 v[212:215], v[140:143], v[92:95], v[212:215]
    v_mfma_f32_16x16x32_bf16 v[208:211], v[136:139], v[92:95], v[208:211]
    ds_read_b128 v[92:95], v11 offset:7168
    s_waitcnt lgkmcnt(4)
    v_mfma_f32_16x16x32_bf16 v[208:211], v[160:163], v[96:99], v[208:211]
    v_cvt_pk_bf16_f32 v118, v204, v205
    v_cvt_pk_bf16_f32 v119, v206, v207
    v_mfma_f32_16x16x32_bf16 v[212:215], v[164:167], v[96:99], v[212:215]
    ds_read_b128 v[96:99], v11 offset:22528
    v_mfma_f32_16x16x32_bf16 v[212:215], v[172:175], v[100:103], v[212:215]
    v_cvt_pk_bf16_f32 v116, v200, v201
    v_cvt_pk_bf16_f32 v117, v202, v203
    v_mfma_f32_16x16x32_bf16 v[208:211], v[168:171], v[100:103], v[208:211]
    ds_read_b128 v[100:103], v11 offset:23552
    s_waitcnt lgkmcnt(4)
    v_mfma_f32_16x16x32_bf16 v[208:211], v[24:27], v[104:107], v[208:211]
    buffer_store_dwordx4 v[116:119], v16, s[56:59], s81 offen sc1
    v_mfma_f32_16x16x32_bf16 v[212:215], v[28:31], v[104:107], v[212:215]
    ds_read_b128 v[104:107], v10 offset:6144
    v_mfma_f32_16x16x32_bf16 v[212:215], v[44:47], v[108:111], v[212:215]
    v_mfma_f32_16x16x32_bf16 v[208:211], v[40:43], v[108:111], v[208:211]
    ds_read_b128 v[108:111], v10 offset:7168
    s_waitcnt lgkmcnt(4)
    v_mfma_f32_16x16x32_bf16 v[216:219], v[128:131], v[88:91], v[216:219]
    s_barrier
    v_mfma_f32_16x16x32_bf16 v[220:223], v[132:135], v[88:91], v[220:223]
    ds_read_b128 v[88:91], v11 offset:8192
    v_mfma_f32_16x16x32_bf16 v[220:223], v[140:143], v[92:95], v[220:223]
    v_mfma_f32_16x16x32_bf16 v[216:219], v[136:139], v[92:95], v[216:219]
    ds_read_b128 v[92:95], v11 offset:9216
    s_waitcnt lgkmcnt(4)
    v_mfma_f32_16x16x32_bf16 v[216:219], v[160:163], v[96:99], v[216:219]
    v_cvt_pk_bf16_f32 v122, v212, v213
    v_cvt_pk_bf16_f32 v123, v214, v215
    v_mfma_f32_16x16x32_bf16 v[220:223], v[164:167], v[96:99], v[220:223]
    ds_read_b128 v[96:99], v11 offset:24576
    v_mfma_f32_16x16x32_bf16 v[220:223], v[172:175], v[100:103], v[220:223]
    v_cvt_pk_bf16_f32 v120, v208, v209
    v_cvt_pk_bf16_f32 v121, v210, v211
    v_mfma_f32_16x16x32_bf16 v[216:219], v[168:171], v[100:103], v[216:219]
    ds_read_b128 v[100:103], v11 offset:25600
    s_waitcnt lgkmcnt(4)
    v_mfma_f32_16x16x32_bf16 v[216:219], v[24:27], v[104:107], v[216:219]
    buffer_store_dwordx4 v[120:123], v16, s[56:59], s82 offen sc1
    v_mfma_f32_16x16x32_bf16 v[220:223], v[28:31], v[104:107], v[220:223]
    ds_read_b128 v[104:107], v10 offset:8192
    v_mfma_f32_16x16x32_bf16 v[220:223], v[44:47], v[108:111], v[220:223]
    v_mfma_f32_16x16x32_bf16 v[216:219], v[40:43], v[108:111], v[216:219]
    ds_read_b128 v[108:111], v10 offset:9216
    s_waitcnt lgkmcnt(4)
    v_mfma_f32_16x16x32_bf16 v[224:227], v[144:147], v[88:91], v[224:227]
    v_mfma_f32_16x16x32_bf16 v[228:231], v[148:151], v[88:91], v[228:231]
    ds_read_b128 v[88:91], v11 offset:10240
    v_mfma_f32_16x16x32_bf16 v[228:231], v[156:159], v[92:95], v[228:231]
    v_mfma_f32_16x16x32_bf16 v[224:227], v[152:155], v[92:95], v[224:227]
    ds_read_b128 v[92:95], v11 offset:11264
    s_waitcnt lgkmcnt(4)
    v_mfma_f32_16x16x32_bf16 v[224:227], v[176:179], v[96:99], v[224:227]
    v_cvt_pk_bf16_f32 v126, v220, v221
    v_cvt_pk_bf16_f32 v127, v222, v223
    v_mfma_f32_16x16x32_bf16 v[228:231], v[180:183], v[96:99], v[228:231]
    ds_read_b128 v[96:99], v11 offset:26624
    v_mfma_f32_16x16x32_bf16 v[228:231], v[188:191], v[100:103], v[228:231]
    v_cvt_pk_bf16_f32 v124, v216, v217
    v_cvt_pk_bf16_f32 v125, v218, v219
    v_mfma_f32_16x16x32_bf16 v[224:227], v[184:187], v[100:103], v[224:227]
    ds_read_b128 v[100:103], v11 offset:27648
    s_waitcnt lgkmcnt(4)
    v_mfma_f32_16x16x32_bf16 v[224:227], v[56:59], v[104:107], v[224:227]
    buffer_store_dwordx4 v[124:127], v16, s[56:59], s83 offen sc1
    v_mfma_f32_16x16x32_bf16 v[228:231], v[60:63], v[104:107], v[228:231]
    ds_read_b128 v[104:107], v10 offset:10240
    v_mfma_f32_16x16x32_bf16 v[228:231], v[76:79], v[108:111], v[228:231]
    v_mfma_f32_16x16x32_bf16 v[224:227], v[72:75], v[108:111], v[224:227]
    ds_read_b128 v[108:111], v10 offset:11264
    s_waitcnt lgkmcnt(4)
    v_mfma_f32_16x16x32_bf16 v[232:235], v[144:147], v[88:91], v[232:235]
    v_mfma_f32_16x16x32_bf16 v[236:239], v[148:151], v[88:91], v[236:239]
    ds_read_b128 v[88:91], v11 offset:12288
    v_mfma_f32_16x16x32_bf16 v[236:239], v[156:159], v[92:95], v[236:239]
    v_mfma_f32_16x16x32_bf16 v[232:235], v[152:155], v[92:95], v[232:235]
    ds_read_b128 v[92:95], v11 offset:13312
    s_waitcnt lgkmcnt(4)
    v_mfma_f32_16x16x32_bf16 v[232:235], v[176:179], v[96:99], v[232:235]
    v_cvt_pk_bf16_f32 v114, v228, v229
    v_cvt_pk_bf16_f32 v115, v230, v231
    v_mfma_f32_16x16x32_bf16 v[236:239], v[180:183], v[96:99], v[236:239]
    ds_read_b128 v[96:99], v11 offset:28672
    v_mfma_f32_16x16x32_bf16 v[236:239], v[188:191], v[100:103], v[236:239]
    v_cvt_pk_bf16_f32 v112, v224, v225
    v_cvt_pk_bf16_f32 v113, v226, v227
    v_mfma_f32_16x16x32_bf16 v[232:235], v[184:187], v[100:103], v[232:235]
    ds_read_b128 v[100:103], v11 offset:29696
    s_waitcnt lgkmcnt(4)
    v_mfma_f32_16x16x32_bf16 v[232:235], v[56:59], v[104:107], v[232:235]
    buffer_store_dwordx4 v[112:115], v16, s[56:59], s84 offen sc1
    v_mfma_f32_16x16x32_bf16 v[236:239], v[60:63], v[104:107], v[236:239]
    ds_read_b128 v[104:107], v10 offset:12288
    v_mfma_f32_16x16x32_bf16 v[236:239], v[76:79], v[108:111], v[236:239]
    v_mfma_f32_16x16x32_bf16 v[232:235], v[72:75], v[108:111], v[232:235]
    ds_read_b128 v[108:111], v10 offset:13312
    s_waitcnt lgkmcnt(4)
    v_mfma_f32_16x16x32_bf16 v[240:243], v[144:147], v[88:91], v[240:243]
    v_mfma_f32_16x16x32_bf16 v[244:247], v[148:151], v[88:91], v[244:247]
    ds_read_b128 v[88:91], v11 offset:14336
    v_mfma_f32_16x16x32_bf16 v[244:247], v[156:159], v[92:95], v[244:247]
    v_mfma_f32_16x16x32_bf16 v[240:243], v[152:155], v[92:95], v[240:243]
    ds_read_b128 v[92:95], v11 offset:15360
    s_waitcnt lgkmcnt(4)
    v_mfma_f32_16x16x32_bf16 v[240:243], v[176:179], v[96:99], v[240:243]
    v_cvt_pk_bf16_f32 v118, v236, v237
    v_cvt_pk_bf16_f32 v119, v238, v239
    v_mfma_f32_16x16x32_bf16 v[244:247], v[180:183], v[96:99], v[244:247]
    ds_read_b128 v[96:99], v11 offset:30720
    v_mfma_f32_16x16x32_bf16 v[244:247], v[188:191], v[100:103], v[244:247]
    v_cvt_pk_bf16_f32 v116, v232, v233
    v_cvt_pk_bf16_f32 v117, v234, v235
    v_mfma_f32_16x16x32_bf16 v[240:243], v[184:187], v[100:103], v[240:243]
    ds_read_b128 v[100:103], v11 offset:31744
    s_waitcnt lgkmcnt(4)
    v_mfma_f32_16x16x32_bf16 v[240:243], v[56:59], v[104:107], v[240:243]
    buffer_store_dwordx4 v[116:119], v16, s[56:59], s85 offen sc1
    v_mfma_f32_16x16x32_bf16 v[244:247], v[60:63], v[104:107], v[244:247]
    ds_read_b128 v[104:107], v10 offset:14336
    v_mfma_f32_16x16x32_bf16 v[244:247], v[76:79], v[108:111], v[244:247]
    v_mfma_f32_16x16x32_bf16 v[240:243], v[72:75], v[108:111], v[240:243]
    ds_read_b128 v[108:111], v10 offset:15360
    s_waitcnt lgkmcnt(4)
    v_mfma_f32_16x16x32_bf16 v[248:251], v[144:147], v[88:91], v[248:251]
    v_mfma_f32_16x16x32_bf16 v[252:255], v[148:151], v[88:91], v[252:255]
    v_mfma_f32_16x16x32_bf16 v[252:255], v[156:159], v[92:95], v[252:255]
    v_mfma_f32_16x16x32_bf16 v[248:251], v[152:155], v[92:95], v[248:251]
    s_waitcnt lgkmcnt(2)
    v_mfma_f32_16x16x32_bf16 v[248:251], v[176:179], v[96:99], v[248:251]
    v_cvt_pk_bf16_f32 v122, v244, v245
    v_cvt_pk_bf16_f32 v123, v246, v247
    v_mfma_f32_16x16x32_bf16 v[252:255], v[180:183], v[96:99], v[252:255]
    v_mfma_f32_16x16x32_bf16 v[252:255], v[188:191], v[100:103], v[252:255]
    v_cvt_pk_bf16_f32 v120, v240, v241
    v_cvt_pk_bf16_f32 v121, v242, v243
    v_mfma_f32_16x16x32_bf16 v[248:251], v[184:187], v[100:103], v[248:251]
    s_waitcnt lgkmcnt(0)
    v_mfma_f32_16x16x32_bf16 v[248:251], v[56:59], v[104:107], v[248:251]
    buffer_store_dwordx4 v[120:123], v16, s[56:59], s86 offen sc1
    v_mfma_f32_16x16x32_bf16 v[252:255], v[60:63], v[104:107], v[252:255]
    v_mfma_f32_16x16x32_bf16 v[252:255], v[76:79], v[108:111], v[252:255]
    v_mfma_f32_16x16x32_bf16 v[248:251], v[72:75], v[108:111], v[248:251]
    s_nop 6
    v_add_u32 v1, s70, v10
    ds_write_b128 v1, v[248:251] offset:49152
    ds_write_b128 v1, v[252:255] offset:50176
    s_waitcnt vmcnt(6)
    s_atomic_add s87, s[30:31], s72
    s_waitcnt vmcnt(5)
    s_atomic_add s87, s[30:31], s73
    s_waitcnt vmcnt(4)
    s_atomic_add s87, s[30:31], s74
    s_waitcnt vmcnt(3)
    s_atomic_add s87, s[30:31], s75
    s_waitcnt vmcnt(2)
    s_atomic_add s87, s[30:31], s76
    s_waitcnt vmcnt(1)
    s_atomic_add s87, s[30:31], s77
    s_waitcnt vmcnt(0)
    s_atomic_add s87, s[30:31], s78
    s_waitcnt lgkmcnt(0)
    s_barrier
L_end:
    s_endpgm
L_pad3:
    s_branch L_back
L_codeend:
.section .rodata,"a"
.p2align 6
.amdhsa_kernel standalone__mha_block_cached__near_ridge_kernel
  .amdhsa_next_free_vgpr 256
  .amdhsa_next_free_sgpr 102
  .amdhsa_accum_offset 256
  .amdhsa_group_segment_fixed_size 0
  .amdhsa_kernarg_size 64
  .amdhsa_user_sgpr_count 2
  .amdhsa_user_sgpr_kernarg_segment_ptr 1
  .amdhsa_system_sgpr_workgroup_id_x 1
.end_amdhsa_kernel
```
